```python
import torch

def _softmax(x, axis=-1):
    return torch.softmax(x, dim=axis)
def _gelu(x):
    return torch.nn.functional.gelu(x, approximate="tanh")
def _silu(x):
    return torch.nn.functional.silu(x)
def _sigmoid(x):
    return torch.sigmoid(x)
def _layernorm(x, axis=-1, eps=1e-5):
    m = x.mean(dim=axis, keepdim=True)
    v = x.var(dim=axis, keepdim=True, unbiased=False)
    return (x - m) / torch.sqrt(v + eps)
def _scatter_add(tgt, idx, src, axis=0):
    return tgt.clone().index_add_(axis, idx, src)
def _segment_sum(src, seg, n):
    out = torch.zeros((n,) + src.shape[1:], dtype=src.dtype)
    return out.index_add_(0, seg, src)
def _pad(x, pw):
    flat = tuple(v for pair in reversed(pw) for v in pair)
    return torch.nn.functional.pad(x, flat)

kernel_name = 'standalone__sliding_block__prompt'

def setup_inputs():

    _w = (lambda a: (lambda t: t.to(torch.bfloat16) if t.is_floating_point() else t)(torch.as_tensor(a)))
    B, S, D = 1, 2048, 512
    return {
        "x": _w((lambda *s: torch.randn(*s, dtype=torch.bfloat16) * 0.4)(B, S, D)),
        "wqkv": _w((lambda *s: torch.randn(*s, dtype=torch.bfloat16) * 0.4)(D, 3 * D)),
        "wo": _w((lambda *s: torch.randn(*s, dtype=torch.bfloat16) * 0.05)(D, D)),
    }

def reference(x, wqkv, wo):
    B, S, D = x.shape
    H = 32; Dh = D // H; W = 256
    qkv = (lambda x, *d: x.permute(*d))((x @ wqkv).reshape(B, S, 3, H, Dh), 2, 0, 3, 1, 4)
    q, k, v = qkv[0], qkv[1], qkv[2]
    scores = torch.einsum("bhqd,bhkd->bhqk", q, k) * (Dh ** -0.5)
    idx = torch.arange(S)
    mask = (idx[:, None] - idx[None, :] >= 0) & (idx[:, None] - idx[None, :] < W)
    scores = torch.where(mask[None, None], scores, -1e9)
    p = _softmax(scores, axis=-1)
    o = torch.einsum("bhqk,bhkd->bhqd", p, v)
    return (lambda x, *d: x.permute(*d))(o, 0, 2, 1, 3).reshape(B, S, D) @ wo
```

```asm
; @launch kernel=qkv_kernel grid=(256,1,1) block=(512,1,1) lds=131072
; @launch kernel=attn_kernel grid=(256,1,1) block=(512,1,1) lds=33280
; @launch kernel=oproj_kernel grid=(256,1,1) block=(512,1,1) lds=140288
.amdgcn_target "amdgcn-amd-amdhsa--gfx950"
.text
.globl qkv_kernel
.p2align 8
.type qkv_kernel,@function
qkv_kernel:
    s_cmp_ge_u32 s2, 256
    s_cbranch_scc1 K1_END
    s_load_dwordx4 s[4:7], s[0:1], 0
    s_load_dwordx2 s[8:9], s[0:1], 40
    v_lshrrev_b32 v2, 6, v0
    v_and_b32 v1, 63, v0
    s_and_b32 s24, s2, 3
    s_lshl_b32 s24, s24, 1
    s_bfe_u32 s25, s2, 0x10003
    s_add_u32 s24, s24, s25
    v_readfirstlane_b32 s26, v2
    s_bfe_u32 s25, s2, 0x10002
    s_lshl_b32 s25, s25, 4
    s_lshr_b32 s27, s2, 4
    s_add_u32 s25, s25, s27
    s_cmp_lt_u32 s26, 4
    s_cbranch_scc1 K1_COMPUTE
    s_sub_u32 s26, s26, 4
    v_lshrrev_b32 v5, 3, v1
    v_and_b32 v6, 7, v1
    s_and_b32 s27, s26, 1
    v_lshrrev_b32 v7, 4, v1
    s_lshl_b32 s29, s27, 2
    v_add_u32 v7, s29, v7
    v_xor_b32 v7, v7, v6
    v_lshlrev_b32 v7, 4, v7
    v_lshl_add_u32 v7, v5, 10, v7
    v_lshrrev_b32 v8, 4, v1
    v_and_b32 v8, 1, v8
    v_lshlrev_b32 v8, 2, v8
    v_xor_b32 v8, v8, v6
    v_lshlrev_b32 v8, 4, v8
    v_mul_u32_u24 v9, 3072, v5
    v_add_u32 v8, v8, v9
    s_lshl_b32 s29, s25, 16
    s_lshl_b32 s30, s26, 13
    s_add_u32 s29, s29, s30
    s_lshl_b32 s30, s26, 10
    s_mul_i32 s31, s26, 49152
    s_lshl_b32 s32, s24, 7
    s_add_u32 s31, s31, s32
    s_lshl_b32 s32, s26, 11
    s_add_u32 s32, s32, 0x8000
    s_waitcnt lgkmcnt(0)
    s_mov_b32 s12, s4
    s_and_b32 s13, s5, 0xffff
    s_mov_b32 s14, 0x200000
    s_mov_b32 s15, 0x00020000
    s_mov_b32 s16, s6
    s_and_b32 s17, s7, 0xffff
    s_mov_b32 s18, 0x180000
    s_mov_b32 s19, 0x00020000
    s_lshr_b32 s39, s2, 3
    s_add_u32 s36, s39, 0
    s_and_b32 s36, s36, 7
    s_lshl_b32 s37, s36, 7
    s_add_u32 s37, s37, s29
    s_mul_i32 s38, s36, 196608
    s_add_u32 s38, s38, s31
    s_add_u32 s33, s37, 0
    s_add_u32 m0, s30, 0
    s_nop 0
    buffer_load_dwordx4 v7, s[12:15], s33 offen lds
    s_add_u32 s33, s37, 32768
    s_add_u32 m0, s30, 4096
    s_nop 0
    buffer_load_dwordx4 v7, s[12:15], s33 offen lds
    s_add_u32 s33, s38, 0
    s_add_u32 m0, s32, 0
    s_nop 0
    buffer_load_dwordx4 v8, s[16:19], s33 offen lds
    s_add_u32 s33, s38, 24576
    s_add_u32 m0, s32, 1024
    s_nop 0
    buffer_load_dwordx4 v8, s[16:19], s33 offen lds
    s_add_u32 s33, s38, 1024
    s_add_u32 m0, s32, 8192
    s_nop 0
    buffer_load_dwordx4 v8, s[16:19], s33 offen lds
    s_add_u32 s33, s38, 25600
    s_add_u32 m0, s32, 9216
    s_nop 0
    buffer_load_dwordx4 v8, s[16:19], s33 offen lds
    s_add_u32 s33, s38, 2048
    s_add_u32 m0, s32, 16384
    s_nop 0
    buffer_load_dwordx4 v8, s[16:19], s33 offen lds
    s_add_u32 s33, s38, 26624
    s_add_u32 m0, s32, 17408
    s_nop 0
    buffer_load_dwordx4 v8, s[16:19], s33 offen lds
    s_add_u32 s36, s39, 1
    s_and_b32 s36, s36, 7
    s_lshl_b32 s37, s36, 7
    s_add_u32 s37, s37, s29
    s_mul_i32 s38, s36, 196608
    s_add_u32 s38, s38, s31
    s_add_u32 s33, s37, 0
    s_add_u32 m0, s30, 8192
    s_nop 0
    buffer_load_dwordx4 v7, s[12:15], s33 offen lds
    s_add_u32 s33, s37, 32768
    s_add_u32 m0, s30, 12288
    s_nop 0
    buffer_load_dwordx4 v7, s[12:15], s33 offen lds
    s_add_u32 s33, s38, 0
    s_add_u32 m0, s32, 24576
    s_nop 0
    buffer_load_dwordx4 v8, s[16:19], s33 offen lds
    s_add_u32 s33, s38, 24576
    s_add_u32 m0, s32, 25600
    s_nop 0
    buffer_load_dwordx4 v8, s[16:19], s33 offen lds
    s_add_u32 s33, s38, 1024
    s_add_u32 m0, s32, 32768
    s_nop 0
    buffer_load_dwordx4 v8, s[16:19], s33 offen lds
    s_add_u32 s33, s38, 25600
    s_add_u32 m0, s32, 33792
    s_nop 0
    buffer_load_dwordx4 v8, s[16:19], s33 offen lds
    s_add_u32 s33, s38, 2048
    s_add_u32 m0, s32, 40960
    s_nop 0
    buffer_load_dwordx4 v8, s[16:19], s33 offen lds
    s_add_u32 s33, s38, 26624
    s_add_u32 m0, s32, 41984
    s_nop 0
    buffer_load_dwordx4 v8, s[16:19], s33 offen lds
    s_waitcnt vmcnt(8)
    s_barrier
    s_add_u32 s36, s39, 2
    s_and_b32 s36, s36, 7
    s_lshl_b32 s37, s36, 7
    s_add_u32 s37, s37, s29
    s_mul_i32 s38, s36, 196608
    s_add_u32 s38, s38, s31
    s_add_u32 s33, s37, 0
    s_add_u32 m0, s30, 16384
    s_nop 0
    buffer_load_dwordx4 v7, s[12:15], s33 offen lds
    s_add_u32 s33, s37, 32768
    s_add_u32 m0, s30, 20480
    s_nop 0
    buffer_load_dwordx4 v7, s[12:15], s33 offen lds
    s_add_u32 s33, s38, 0
    s_add_u32 m0, s32, 49152
    s_nop 0
    buffer_load_dwordx4 v8, s[16:19], s33 offen lds
    s_add_u32 s33, s38, 24576
    s_add_u32 m0, s32, 50176
    s_nop 0
    buffer_load_dwordx4 v8, s[16:19], s33 offen lds
    s_add_u32 s33, s38, 1024
    s_add_u32 m0, s32, 57344
    s_nop 0
    buffer_load_dwordx4 v8, s[16:19], s33 offen lds
    s_add_u32 s33, s38, 25600
    s_add_u32 m0, s32, 58368
    s_nop 0
    buffer_load_dwordx4 v8, s[16:19], s33 offen lds
    s_add_u32 s33, s38, 2048
    s_add_u32 m0, s32, 65536
    s_nop 0
    buffer_load_dwordx4 v8, s[16:19], s33 offen lds
    s_add_u32 s33, s38, 26624
    s_add_u32 m0, s32, 66560
    s_nop 0
    buffer_load_dwordx4 v8, s[16:19], s33 offen lds
    s_add_u32 s36, s39, 3
    s_and_b32 s36, s36, 7
    s_lshl_b32 s37, s36, 7
    s_add_u32 s37, s37, s29
    s_mul_i32 s38, s36, 196608
    s_add_u32 s38, s38, s31
    s_add_u32 s33, s37, 0
    s_add_u32 m0, s30, 24576
    s_nop 0
    buffer_load_dwordx4 v7, s[12:15], s33 offen lds
    s_add_u32 s33, s37, 32768
    s_add_u32 m0, s30, 28672
    s_nop 0
    buffer_load_dwordx4 v7, s[12:15], s33 offen lds
    s_add_u32 s33, s38, 0
    s_add_u32 m0, s32, 73728
    s_nop 0
    buffer_load_dwordx4 v8, s[16:19], s33 offen lds
    s_add_u32 s33, s38, 24576
    s_add_u32 m0, s32, 74752
    s_nop 0
    buffer_load_dwordx4 v8, s[16:19], s33 offen lds
    s_add_u32 s33, s38, 1024
    s_add_u32 m0, s32, 81920
    s_nop 0
    buffer_load_dwordx4 v8, s[16:19], s33 offen lds
    s_add_u32 s33, s38, 25600
    s_add_u32 m0, s32, 82944
    s_nop 0
    buffer_load_dwordx4 v8, s[16:19], s33 offen lds
    s_add_u32 s33, s38, 2048
    s_add_u32 m0, s32, 90112
    s_nop 0
    buffer_load_dwordx4 v8, s[16:19], s33 offen lds
    s_add_u32 s33, s38, 26624
    s_add_u32 m0, s32, 91136
    s_nop 0
    buffer_load_dwordx4 v8, s[16:19], s33 offen lds
    s_waitcnt vmcnt(16)
    s_barrier
    s_add_u32 s36, s39, 4
    s_and_b32 s36, s36, 7
    s_lshl_b32 s37, s36, 7
    s_add_u32 s37, s37, s29
    s_mul_i32 s38, s36, 196608
    s_add_u32 s38, s38, s31
    s_add_u32 s33, s37, 0
    s_add_u32 m0, s30, 0
    s_nop 0
    buffer_load_dwordx4 v7, s[12:15], s33 offen lds
    s_add_u32 s33, s37, 32768
    s_add_u32 m0, s30, 4096
    s_nop 0
    buffer_load_dwordx4 v7, s[12:15], s33 offen lds
    s_add_u32 s33, s38, 0
    s_add_u32 m0, s32, 0
    s_nop 0
    buffer_load_dwordx4 v8, s[16:19], s33 offen lds
    s_add_u32 s33, s38, 24576
    s_add_u32 m0, s32, 1024
    s_nop 0
    buffer_load_dwordx4 v8, s[16:19], s33 offen lds
    s_add_u32 s33, s38, 1024
    s_add_u32 m0, s32, 8192
    s_nop 0
    buffer_load_dwordx4 v8, s[16:19], s33 offen lds
    s_add_u32 s33, s38, 25600
    s_add_u32 m0, s32, 9216
    s_nop 0
    buffer_load_dwordx4 v8, s[16:19], s33 offen lds
    s_add_u32 s33, s38, 2048
    s_add_u32 m0, s32, 16384
    s_nop 0
    buffer_load_dwordx4 v8, s[16:19], s33 offen lds
    s_add_u32 s33, s38, 26624
    s_add_u32 m0, s32, 17408
    s_nop 0
    buffer_load_dwordx4 v8, s[16:19], s33 offen lds
    s_waitcnt vmcnt(16)
    s_barrier
    s_add_u32 s36, s39, 5
    s_and_b32 s36, s36, 7
    s_lshl_b32 s37, s36, 7
    s_add_u32 s37, s37, s29
    s_mul_i32 s38, s36, 196608
    s_add_u32 s38, s38, s31
    s_add_u32 s33, s37, 0
    s_add_u32 m0, s30, 8192
    s_nop 0
    buffer_load_dwordx4 v7, s[12:15], s33 offen lds
    s_add_u32 s33, s37, 32768
    s_add_u32 m0, s30, 12288
    s_nop 0
    buffer_load_dwordx4 v7, s[12:15], s33 offen lds
    s_add_u32 s33, s38, 0
    s_add_u32 m0, s32, 24576
    s_nop 0
    buffer_load_dwordx4 v8, s[16:19], s33 offen lds
    s_add_u32 s33, s38, 24576
    s_add_u32 m0, s32, 25600
    s_nop 0
    buffer_load_dwordx4 v8, s[16:19], s33 offen lds
    s_add_u32 s33, s38, 1024
    s_add_u32 m0, s32, 32768
    s_nop 0
    buffer_load_dwordx4 v8, s[16:19], s33 offen lds
    s_add_u32 s33, s38, 25600
    s_add_u32 m0, s32, 33792
    s_nop 0
    buffer_load_dwordx4 v8, s[16:19], s33 offen lds
    s_add_u32 s33, s38, 2048
    s_add_u32 m0, s32, 40960
    s_nop 0
    buffer_load_dwordx4 v8, s[16:19], s33 offen lds
    s_add_u32 s33, s38, 26624
    s_add_u32 m0, s32, 41984
    s_nop 0
    buffer_load_dwordx4 v8, s[16:19], s33 offen lds
    s_waitcnt vmcnt(16)
    s_barrier
    s_add_u32 s36, s39, 6
    s_and_b32 s36, s36, 7
    s_lshl_b32 s37, s36, 7
    s_add_u32 s37, s37, s29
    s_mul_i32 s38, s36, 196608
    s_add_u32 s38, s38, s31
    s_add_u32 s33, s37, 0
    s_add_u32 m0, s30, 16384
    s_nop 0
    buffer_load_dwordx4 v7, s[12:15], s33 offen lds
    s_add_u32 s33, s37, 32768
    s_add_u32 m0, s30, 20480
    s_nop 0
    buffer_load_dwordx4 v7, s[12:15], s33 offen lds
    s_add_u32 s33, s38, 0
    s_add_u32 m0, s32, 49152
    s_nop 0
    buffer_load_dwordx4 v8, s[16:19], s33 offen lds
    s_add_u32 s33, s38, 24576
    s_add_u32 m0, s32, 50176
    s_nop 0
    buffer_load_dwordx4 v8, s[16:19], s33 offen lds
    s_add_u32 s33, s38, 1024
    s_add_u32 m0, s32, 57344
    s_nop 0
    buffer_load_dwordx4 v8, s[16:19], s33 offen lds
    s_add_u32 s33, s38, 25600
    s_add_u32 m0, s32, 58368
    s_nop 0
    buffer_load_dwordx4 v8, s[16:19], s33 offen lds
    s_add_u32 s33, s38, 2048
    s_add_u32 m0, s32, 65536
    s_nop 0
    buffer_load_dwordx4 v8, s[16:19], s33 offen lds
    s_add_u32 s33, s38, 26624
    s_add_u32 m0, s32, 66560
    s_nop 0
    buffer_load_dwordx4 v8, s[16:19], s33 offen lds
    s_waitcnt vmcnt(16)
    s_barrier
    s_add_u32 s36, s39, 7
    s_and_b32 s36, s36, 7
    s_lshl_b32 s37, s36, 7
    s_add_u32 s37, s37, s29
    s_mul_i32 s38, s36, 196608
    s_add_u32 s38, s38, s31
    s_add_u32 s33, s37, 0
    s_add_u32 m0, s30, 24576
    s_nop 0
    buffer_load_dwordx4 v7, s[12:15], s33 offen lds
    s_add_u32 s33, s37, 32768
    s_add_u32 m0, s30, 28672
    s_nop 0
    buffer_load_dwordx4 v7, s[12:15], s33 offen lds
    s_add_u32 s33, s38, 0
    s_add_u32 m0, s32, 73728
    s_nop 0
    buffer_load_dwordx4 v8, s[16:19], s33 offen lds
    s_add_u32 s33, s38, 24576
    s_add_u32 m0, s32, 74752
    s_nop 0
    buffer_load_dwordx4 v8, s[16:19], s33 offen lds
    s_add_u32 s33, s38, 1024
    s_add_u32 m0, s32, 81920
    s_nop 0
    buffer_load_dwordx4 v8, s[16:19], s33 offen lds
    s_add_u32 s33, s38, 25600
    s_add_u32 m0, s32, 82944
    s_nop 0
    buffer_load_dwordx4 v8, s[16:19], s33 offen lds
    s_add_u32 s33, s38, 2048
    s_add_u32 m0, s32, 90112
    s_nop 0
    buffer_load_dwordx4 v8, s[16:19], s33 offen lds
    s_add_u32 s33, s38, 26624
    s_add_u32 m0, s32, 91136
    s_nop 0
    buffer_load_dwordx4 v8, s[16:19], s33 offen lds
    s_waitcnt vmcnt(16)
    s_barrier
    s_waitcnt vmcnt(8)
    s_barrier
    s_waitcnt vmcnt(0)
    s_barrier
    s_endpgm
K1_COMPUTE:
    v_and_b32 v3, 31, v1
    v_lshrrev_b32 v4, 5, v1
    s_and_b32 s27, s26, 1
    s_lshr_b32 s28, s26, 1
    s_lshl_b32 s29, s27, 5
    v_add_u32 v9, s29, v3
    v_lshrrev_b32 v10, 1, v9
    v_and_b32 v10, 7, v10
    v_lshlrev_b32 v9, 7, v9
    v_add_u32 v11, 0, v4
    v_xor_b32 v11, v11, v10
    v_lshl_add_u32 v12, v11, 4, v9
    v_add_u32 v11, 2, v4
    v_xor_b32 v11, v11, v10
    v_lshl_add_u32 v13, v11, 4, v9
    v_add_u32 v11, 4, v4
    v_xor_b32 v11, v11, v10
    v_lshl_add_u32 v14, v11, 4, v9
    v_add_u32 v11, 6, v4
    v_xor_b32 v11, v11, v10
    v_lshl_add_u32 v15, v11, 4, v9
    v_lshrrev_b32 v9, 2, v1
    v_and_b32 v9, 3, v9
    v_lshrrev_b32 v10, 1, v9
    v_xor_b32 v10, s28, v10
    v_lshlrev_b32 v10, 6, v10
    v_lshl_add_u32 v9, v4, 3, v9
    v_lshl_add_u32 v10, v9, 7, v10
    v_lshrrev_b32 v9, 4, v1
    v_and_b32 v9, 1, v9
    v_lshl_add_u32 v10, v9, 5, v10
    v_and_b32 v9, 3, v1
    v_lshl_add_u32 v10, v9, 3, v10
    v_add_u32 v10, 0x8000, v10
    v_add_u32 v11, 0xc000, v10
    v_lshlrev_b32 v5, 5, v3
    v_lshl_add_u32 v5, v4, 4, v5
    v_and_b32 v6, 15, v1
    v_lshlrev_b32 v6, 5, v6
    v_lshl_add_u32 v6, v4, 4, v6
    v_lshrrev_b32 v9, 4, v3
    v_mul_u32_u24 v9, 196608, v9
    v_add_u32 v6, v9, v6
    v_mov_b32 v16, 0
    v_mov_b32 v17, 0
    v_mov_b32 v18, 0
    v_mov_b32 v19, 0
    v_mov_b32 v20, 0
    v_mov_b32 v21, 0
    v_mov_b32 v22, 0
    v_mov_b32 v23, 0
    v_mov_b32 v24, 0
    v_mov_b32 v25, 0
    v_mov_b32 v26, 0
    v_mov_b32 v27, 0
    v_mov_b32 v28, 0
    v_mov_b32 v29, 0
    v_mov_b32 v30, 0
    v_mov_b32 v31, 0
    v_mov_b32 v32, 0
    v_mov_b32 v33, 0
    v_mov_b32 v34, 0
    v_mov_b32 v35, 0
    v_mov_b32 v36, 0
    v_mov_b32 v37, 0
    v_mov_b32 v38, 0
    v_mov_b32 v39, 0
    v_mov_b32 v40, 0
    v_mov_b32 v41, 0
    v_mov_b32 v42, 0
    v_mov_b32 v43, 0
    v_mov_b32 v44, 0
    v_mov_b32 v45, 0
    v_mov_b32 v46, 0
    v_mov_b32 v47, 0
    v_mov_b32 v48, 0
    v_mov_b32 v49, 0
    v_mov_b32 v50, 0
    v_mov_b32 v51, 0
    v_mov_b32 v52, 0
    v_mov_b32 v53, 0
    v_mov_b32 v54, 0
    v_mov_b32 v55, 0
    v_mov_b32 v56, 0
    v_mov_b32 v57, 0
    v_mov_b32 v58, 0
    v_mov_b32 v59, 0
    v_mov_b32 v60, 0
    v_mov_b32 v61, 0
    v_mov_b32 v62, 0
    v_mov_b32 v63, 0
    s_mul_i32 s31, s24, 786432
    s_mul_i32 s32, s28, 393216
    s_add_u32 s31, s31, s32
    s_lshl_b32 s32, s25, 11
    s_add_u32 s31, s31, s32
    s_lshl_b32 s32, s27, 10
    s_add_u32 s31, s31, s32
    s_add_u32 s32, s31, 196608
    s_add_u32 s33, s31, 65536
    s_add_u32 s34, s33, 196608
    s_add_u32 s35, s31, 131072
    s_waitcnt lgkmcnt(0)
    s_mov_b32 s20, s8
    s_and_b32 s21, s9, 0xffff
    s_mov_b32 s22, 0x800000
    s_mov_b32 s23, 0x00020000
    s_barrier
    ds_read_b128 v[64:67], v12 offset:0
    ds_read_b64_tr_b16 v[68:69], v10 offset:0
    ds_read_b64_tr_b16 v[70:71], v10 offset:512
    ds_read_b64_tr_b16 v[72:73], v10 offset:8192
    ds_read_b64_tr_b16 v[74:75], v10 offset:8704
    ds_read_b64_tr_b16 v[76:77], v10 offset:16384
    ds_read_b64_tr_b16 v[78:79], v10 offset:16896
    ds_read_b128 v[80:83], v13 offset:0
    ds_read_b64_tr_b16 v[84:85], v10 offset:2048
    ds_read_b64_tr_b16 v[86:87], v10 offset:2560
    ds_read_b64_tr_b16 v[88:89], v10 offset:10240
    ds_read_b64_tr_b16 v[90:91], v10 offset:10752
    ds_read_b64_tr_b16 v[92:93], v10 offset:18432
    ds_read_b64_tr_b16 v[94:95], v10 offset:18944
    s_waitcnt lgkmcnt(7)
    v_mfma_f32_32x32x16_bf16 v[16:31], v[68:71], v[64:67], v[16:31]
    v_mfma_f32_32x32x16_bf16 v[32:47], v[72:75], v[64:67], v[32:47]
    v_mfma_f32_32x32x16_bf16 v[48:63], v[64:67], v[76:79], v[48:63]
    ds_read_b128 v[64:67], v14 offset:0
    ds_read_b64_tr_b16 v[68:69], v10 offset:4096
    ds_read_b64_tr_b16 v[70:71], v10 offset:4608
    ds_read_b64_tr_b16 v[72:73], v10 offset:12288
    ds_read_b64_tr_b16 v[74:75], v10 offset:12800
    ds_read_b64_tr_b16 v[76:77], v10 offset:20480
    ds_read_b64_tr_b16 v[78:79], v10 offset:20992
    s_waitcnt lgkmcnt(7)
    v_mfma_f32_32x32x16_bf16 v[16:31], v[84:87], v[80:83], v[16:31]
    v_mfma_f32_32x32x16_bf16 v[32:47], v[88:91], v[80:83], v[32:47]
    v_mfma_f32_32x32x16_bf16 v[48:63], v[80:83], v[92:95], v[48:63]
    ds_read_b128 v[80:83], v15 offset:0
    ds_read_b64_tr_b16 v[84:85], v10 offset:6144
    ds_read_b64_tr_b16 v[86:87], v10 offset:6656
    ds_read_b64_tr_b16 v[88:89], v10 offset:14336
    ds_read_b64_tr_b16 v[90:91], v10 offset:14848
    ds_read_b64_tr_b16 v[92:93], v10 offset:22528
    ds_read_b64_tr_b16 v[94:95], v10 offset:23040
    s_waitcnt lgkmcnt(7)
    v_mfma_f32_32x32x16_bf16 v[16:31], v[68:71], v[64:67], v[16:31]
    v_mfma_f32_32x32x16_bf16 v[32:47], v[72:75], v[64:67], v[32:47]
    v_mfma_f32_32x32x16_bf16 v[48:63], v[64:67], v[76:79], v[48:63]
    s_waitcnt lgkmcnt(0)
    v_mfma_f32_32x32x16_bf16 v[16:31], v[84:87], v[80:83], v[16:31]
    v_mfma_f32_32x32x16_bf16 v[32:47], v[88:91], v[80:83], v[32:47]
    v_mfma_f32_32x32x16_bf16 v[48:63], v[80:83], v[92:95], v[48:63]
    s_barrier
    ds_read_b128 v[64:67], v12 offset:8192
    ds_read_b64_tr_b16 v[68:69], v10 offset:24576
    ds_read_b64_tr_b16 v[70:71], v10 offset:25088
    ds_read_b64_tr_b16 v[72:73], v10 offset:32768
    ds_read_b64_tr_b16 v[74:75], v10 offset:33280
    ds_read_b64_tr_b16 v[76:77], v10 offset:40960
    ds_read_b64_tr_b16 v[78:79], v10 offset:41472
    ds_read_b128 v[80:83], v13 offset:8192
    ds_read_b64_tr_b16 v[84:85], v10 offset:26624
    ds_read_b64_tr_b16 v[86:87], v10 offset:27136
    ds_read_b64_tr_b16 v[88:89], v10 offset:34816
    ds_read_b64_tr_b16 v[90:91], v10 offset:35328
    ds_read_b64_tr_b16 v[92:93], v10 offset:43008
    ds_read_b64_tr_b16 v[94:95], v10 offset:43520
    s_waitcnt lgkmcnt(7)
    v_mfma_f32_32x32x16_bf16 v[16:31], v[68:71], v[64:67], v[16:31]
    v_mfma_f32_32x32x16_bf16 v[32:47], v[72:75], v[64:67], v[32:47]
    v_mfma_f32_32x32x16_bf16 v[48:63], v[64:67], v[76:79], v[48:63]
    ds_read_b128 v[64:67], v14 offset:8192
    ds_read_b64_tr_b16 v[68:69], v10 offset:28672
    ds_read_b64_tr_b16 v[70:71], v10 offset:29184
    ds_read_b64_tr_b16 v[72:73], v10 offset:36864
    ds_read_b64_tr_b16 v[74:75], v10 offset:37376
    ds_read_b64_tr_b16 v[76:77], v10 offset:45056
    ds_read_b64_tr_b16 v[78:79], v10 offset:45568
    s_waitcnt lgkmcnt(7)
    v_mfma_f32_32x32x16_bf16 v[16:31], v[84:87], v[80:83], v[16:31]
    v_mfma_f32_32x32x16_bf16 v[32:47], v[88:91], v[80:83], v[32:47]
    v_mfma_f32_32x32x16_bf16 v[48:63], v[80:83], v[92:95], v[48:63]
    ds_read_b128 v[80:83], v15 offset:8192
    ds_read_b64_tr_b16 v[84:85], v10 offset:30720
    ds_read_b64_tr_b16 v[86:87], v10 offset:31232
    ds_read_b64_tr_b16 v[88:89], v10 offset:38912
    ds_read_b64_tr_b16 v[90:91], v10 offset:39424
    ds_read_b64_tr_b16 v[92:93], v10 offset:47104
    ds_read_b64_tr_b16 v[94:95], v10 offset:47616
    s_waitcnt lgkmcnt(7)
    v_mfma_f32_32x32x16_bf16 v[16:31], v[68:71], v[64:67], v[16:31]
    v_mfma_f32_32x32x16_bf16 v[32:47], v[72:75], v[64:67], v[32:47]
    v_mfma_f32_32x32x16_bf16 v[48:63], v[64:67], v[76:79], v[48:63]
    s_waitcnt lgkmcnt(0)
    v_mfma_f32_32x32x16_bf16 v[16:31], v[84:87], v[80:83], v[16:31]
    v_mfma_f32_32x32x16_bf16 v[32:47], v[88:91], v[80:83], v[32:47]
    v_mfma_f32_32x32x16_bf16 v[48:63], v[80:83], v[92:95], v[48:63]
    s_barrier
    ds_read_b128 v[64:67], v12 offset:16384
    ds_read_b64_tr_b16 v[68:69], v11 offset:0
    ds_read_b64_tr_b16 v[70:71], v11 offset:512
    ds_read_b64_tr_b16 v[72:73], v11 offset:8192
    ds_read_b64_tr_b16 v[74:75], v11 offset:8704
    ds_read_b64_tr_b16 v[76:77], v11 offset:16384
    ds_read_b64_tr_b16 v[78:79], v11 offset:16896
    ds_read_b128 v[80:83], v13 offset:16384
    ds_read_b64_tr_b16 v[84:85], v11 offset:2048
    ds_read_b64_tr_b16 v[86:87], v11 offset:2560
    ds_read_b64_tr_b16 v[88:89], v11 offset:10240
    ds_read_b64_tr_b16 v[90:91], v11 offset:10752
    ds_read_b64_tr_b16 v[92:93], v11 offset:18432
    ds_read_b64_tr_b16 v[94:95], v11 offset:18944
    s_waitcnt lgkmcnt(7)
    v_mfma_f32_32x32x16_bf16 v[16:31], v[68:71], v[64:67], v[16:31]
    v_mfma_f32_32x32x16_bf16 v[32:47], v[72:75], v[64:67], v[32:47]
    v_mfma_f32_32x32x16_bf16 v[48:63], v[64:67], v[76:79], v[48:63]
    ds_read_b128 v[64:67], v14 offset:16384
    ds_read_b64_tr_b16 v[68:69], v11 offset:4096
    ds_read_b64_tr_b16 v[70:71], v11 offset:4608
    ds_read_b64_tr_b16 v[72:73], v11 offset:12288
    ds_read_b64_tr_b16 v[74:75], v11 offset:12800
    ds_read_b64_tr_b16 v[76:77], v11 offset:20480
    ds_read_b64_tr_b16 v[78:79], v11 offset:20992
    s_waitcnt lgkmcnt(7)
    v_mfma_f32_32x32x16_bf16 v[16:31], v[84:87], v[80:83], v[16:31]
    v_mfma_f32_32x32x16_bf16 v[32:47], v[88:91], v[80:83], v[32:47]
    v_mfma_f32_32x32x16_bf16 v[48:63], v[80:83], v[92:95], v[48:63]
    ds_read_b128 v[80:83], v15 offset:16384
    ds_read_b64_tr_b16 v[84:85], v11 offset:6144
    ds_read_b64_tr_b16 v[86:87], v11 offset:6656
    ds_read_b64_tr_b16 v[88:89], v11 offset:14336
    ds_read_b64_tr_b16 v[90:91], v11 offset:14848
    ds_read_b64_tr_b16 v[92:93], v11 offset:22528
    ds_read_b64_tr_b16 v[94:95], v11 offset:23040
    s_waitcnt lgkmcnt(7)
    v_mfma_f32_32x32x16_bf16 v[16:31], v[68:71], v[64:67], v[16:31]
    v_mfma_f32_32x32x16_bf16 v[32:47], v[72:75], v[64:67], v[32:47]
    v_mfma_f32_32x32x16_bf16 v[48:63], v[64:67], v[76:79], v[48:63]
    s_waitcnt lgkmcnt(0)
    v_mfma_f32_32x32x16_bf16 v[16:31], v[84:87], v[80:83], v[16:31]
    v_mfma_f32_32x32x16_bf16 v[32:47], v[88:91], v[80:83], v[32:47]
    v_mfma_f32_32x32x16_bf16 v[48:63], v[80:83], v[92:95], v[48:63]
    s_barrier
    ds_read_b128 v[64:67], v12 offset:24576
    ds_read_b64_tr_b16 v[68:69], v11 offset:24576
    ds_read_b64_tr_b16 v[70:71], v11 offset:25088
    ds_read_b64_tr_b16 v[72:73], v11 offset:32768
    ds_read_b64_tr_b16 v[74:75], v11 offset:33280
    ds_read_b64_tr_b16 v[76:77], v11 offset:40960
    ds_read_b64_tr_b16 v[78:79], v11 offset:41472
    ds_read_b128 v[80:83], v13 offset:24576
    ds_read_b64_tr_b16 v[84:85], v11 offset:26624
    ds_read_b64_tr_b16 v[86:87], v11 offset:27136
    ds_read_b64_tr_b16 v[88:89], v11 offset:34816
    ds_read_b64_tr_b16 v[90:91], v11 offset:35328
    ds_read_b64_tr_b16 v[92:93], v11 offset:43008
    ds_read_b64_tr_b16 v[94:95], v11 offset:43520
    s_waitcnt lgkmcnt(7)
    v_mfma_f32_32x32x16_bf16 v[16:31], v[68:71], v[64:67], v[16:31]
    v_mfma_f32_32x32x16_bf16 v[32:47], v[72:75], v[64:67], v[32:47]
    v_mfma_f32_32x32x16_bf16 v[48:63], v[64:67], v[76:79], v[48:63]
    ds_read_b128 v[64:67], v14 offset:24576
    ds_read_b64_tr_b16 v[68:69], v11 offset:28672
    ds_read_b64_tr_b16 v[70:71], v11 offset:29184
    ds_read_b64_tr_b16 v[72:73], v11 offset:36864
    ds_read_b64_tr_b16 v[74:75], v11 offset:37376
    ds_read_b64_tr_b16 v[76:77], v11 offset:45056
    ds_read_b64_tr_b16 v[78:79], v11 offset:45568
    s_waitcnt lgkmcnt(7)
    v_mfma_f32_32x32x16_bf16 v[16:31], v[84:87], v[80:83], v[16:31]
    v_mfma_f32_32x32x16_bf16 v[32:47], v[88:91], v[80:83], v[32:47]
    v_mfma_f32_32x32x16_bf16 v[48:63], v[80:83], v[92:95], v[48:63]
    ds_read_b128 v[80:83], v15 offset:24576
    ds_read_b64_tr_b16 v[84:85], v11 offset:30720
    ds_read_b64_tr_b16 v[86:87], v11 offset:31232
    ds_read_b64_tr_b16 v[88:89], v11 offset:38912
    ds_read_b64_tr_b16 v[90:91], v11 offset:39424
    ds_read_b64_tr_b16 v[92:93], v11 offset:47104
    ds_read_b64_tr_b16 v[94:95], v11 offset:47616
    s_waitcnt lgkmcnt(7)
    v_mfma_f32_32x32x16_bf16 v[16:31], v[68:71], v[64:67], v[16:31]
    v_mfma_f32_32x32x16_bf16 v[32:47], v[72:75], v[64:67], v[32:47]
    v_mfma_f32_32x32x16_bf16 v[48:63], v[64:67], v[76:79], v[48:63]
    s_waitcnt lgkmcnt(0)
    v_mfma_f32_32x32x16_bf16 v[16:31], v[84:87], v[80:83], v[16:31]
    v_mfma_f32_32x32x16_bf16 v[32:47], v[88:91], v[80:83], v[32:47]
    v_mfma_f32_32x32x16_bf16 v[48:63], v[80:83], v[92:95], v[48:63]
    s_barrier
    ds_read_b128 v[64:67], v12 offset:0
    ds_read_b64_tr_b16 v[68:69], v10 offset:0
    ds_read_b64_tr_b16 v[70:71], v10 offset:512
    ds_read_b64_tr_b16 v[72:73], v10 offset:8192
    ds_read_b64_tr_b16 v[74:75], v10 offset:8704
    ds_read_b64_tr_b16 v[76:77], v10 offset:16384
    ds_read_b64_tr_b16 v[78:79], v10 offset:16896
    ds_read_b128 v[80:83], v13 offset:0
    ds_read_b64_tr_b16 v[84:85], v10 offset:2048
    ds_read_b64_tr_b16 v[86:87], v10 offset:2560
    ds_read_b64_tr_b16 v[88:89], v10 offset:10240
    ds_read_b64_tr_b16 v[90:91], v10 offset:10752
    ds_read_b64_tr_b16 v[92:93], v10 offset:18432
    ds_read_b64_tr_b16 v[94:95], v10 offset:18944
    s_waitcnt lgkmcnt(7)
    v_mfma_f32_32x32x16_bf16 v[16:31], v[68:71], v[64:67], v[16:31]
    v_mfma_f32_32x32x16_bf16 v[32:47], v[72:75], v[64:67], v[32:47]
    v_mfma_f32_32x32x16_bf16 v[48:63], v[64:67], v[76:79], v[48:63]
    ds_read_b128 v[64:67], v14 offset:0
    ds_read_b64_tr_b16 v[68:69], v10 offset:4096
    ds_read_b64_tr_b16 v[70:71], v10 offset:4608
    ds_read_b64_tr_b16 v[72:73], v10 offset:12288
    ds_read_b64_tr_b16 v[74:75], v10 offset:12800
    ds_read_b64_tr_b16 v[76:77], v10 offset:20480
    ds_read_b64_tr_b16 v[78:79], v10 offset:20992
    s_waitcnt lgkmcnt(7)
    v_mfma_f32_32x32x16_bf16 v[16:31], v[84:87], v[80:83], v[16:31]
    v_mfma_f32_32x32x16_bf16 v[32:47], v[88:91], v[80:83], v[32:47]
    v_mfma_f32_32x32x16_bf16 v[48:63], v[80:83], v[92:95], v[48:63]
    ds_read_b128 v[80:83], v15 offset:0
    ds_read_b64_tr_b16 v[84:85], v10 offset:6144
    ds_read_b64_tr_b16 v[86:87], v10 offset:6656
    ds_read_b64_tr_b16 v[88:89], v10 offset:14336
    ds_read_b64_tr_b16 v[90:91], v10 offset:14848
    ds_read_b64_tr_b16 v[92:93], v10 offset:22528
    ds_read_b64_tr_b16 v[94:95], v10 offset:23040
    s_waitcnt lgkmcnt(7)
    v_mfma_f32_32x32x16_bf16 v[16:31], v[68:71], v[64:67], v[16:31]
    v_mfma_f32_32x32x16_bf16 v[32:47], v[72:75], v[64:67], v[32:47]
    v_mfma_f32_32x32x16_bf16 v[48:63], v[64:67], v[76:79], v[48:63]
    s_waitcnt lgkmcnt(0)
    v_mfma_f32_32x32x16_bf16 v[16:31], v[84:87], v[80:83], v[16:31]
    v_mfma_f32_32x32x16_bf16 v[32:47], v[88:91], v[80:83], v[32:47]
    v_mfma_f32_32x32x16_bf16 v[48:63], v[80:83], v[92:95], v[48:63]
    s_barrier
    ds_read_b128 v[64:67], v12 offset:8192
    ds_read_b64_tr_b16 v[68:69], v10 offset:24576
    ds_read_b64_tr_b16 v[70:71], v10 offset:25088
    ds_read_b64_tr_b16 v[72:73], v10 offset:32768
    ds_read_b64_tr_b16 v[74:75], v10 offset:33280
    ds_read_b64_tr_b16 v[76:77], v10 offset:40960
    ds_read_b64_tr_b16 v[78:79], v10 offset:41472
    ds_read_b128 v[80:83], v13 offset:8192
    ds_read_b64_tr_b16 v[84:85], v10 offset:26624
    ds_read_b64_tr_b16 v[86:87], v10 offset:27136
    ds_read_b64_tr_b16 v[88:89], v10 offset:34816
    ds_read_b64_tr_b16 v[90:91], v10 offset:35328
    ds_read_b64_tr_b16 v[92:93], v10 offset:43008
    ds_read_b64_tr_b16 v[94:95], v10 offset:43520
    s_waitcnt lgkmcnt(7)
    v_mfma_f32_32x32x16_bf16 v[16:31], v[68:71], v[64:67], v[16:31]
    v_mfma_f32_32x32x16_bf16 v[32:47], v[72:75], v[64:67], v[32:47]
    v_mfma_f32_32x32x16_bf16 v[48:63], v[64:67], v[76:79], v[48:63]
    ds_read_b128 v[64:67], v14 offset:8192
    ds_read_b64_tr_b16 v[68:69], v10 offset:28672
    ds_read_b64_tr_b16 v[70:71], v10 offset:29184
    ds_read_b64_tr_b16 v[72:73], v10 offset:36864
    ds_read_b64_tr_b16 v[74:75], v10 offset:37376
    ds_read_b64_tr_b16 v[76:77], v10 offset:45056
    ds_read_b64_tr_b16 v[78:79], v10 offset:45568
    s_waitcnt lgkmcnt(7)
    v_mfma_f32_32x32x16_bf16 v[16:31], v[84:87], v[80:83], v[16:31]
    v_mfma_f32_32x32x16_bf16 v[32:47], v[88:91], v[80:83], v[32:47]
    v_mfma_f32_32x32x16_bf16 v[48:63], v[80:83], v[92:95], v[48:63]
    ds_read_b128 v[80:83], v15 offset:8192
    ds_read_b64_tr_b16 v[84:85], v10 offset:30720
    ds_read_b64_tr_b16 v[86:87], v10 offset:31232
    ds_read_b64_tr_b16 v[88:89], v10 offset:38912
    ds_read_b64_tr_b16 v[90:91], v10 offset:39424
    ds_read_b64_tr_b16 v[92:93], v10 offset:47104
    ds_read_b64_tr_b16 v[94:95], v10 offset:47616
    s_waitcnt lgkmcnt(7)
    v_mfma_f32_32x32x16_bf16 v[16:31], v[68:71], v[64:67], v[16:31]
    v_mfma_f32_32x32x16_bf16 v[32:47], v[72:75], v[64:67], v[32:47]
    v_mfma_f32_32x32x16_bf16 v[48:63], v[64:67], v[76:79], v[48:63]
    s_waitcnt lgkmcnt(0)
    v_mfma_f32_32x32x16_bf16 v[16:31], v[84:87], v[80:83], v[16:31]
    v_mfma_f32_32x32x16_bf16 v[32:47], v[88:91], v[80:83], v[32:47]
    v_mfma_f32_32x32x16_bf16 v[48:63], v[80:83], v[92:95], v[48:63]
    s_barrier
    ds_read_b128 v[64:67], v12 offset:16384
    ds_read_b64_tr_b16 v[68:69], v11 offset:0
    ds_read_b64_tr_b16 v[70:71], v11 offset:512
    ds_read_b64_tr_b16 v[72:73], v11 offset:8192
    ds_read_b64_tr_b16 v[74:75], v11 offset:8704
    ds_read_b64_tr_b16 v[76:77], v11 offset:16384
    ds_read_b64_tr_b16 v[78:79], v11 offset:16896
    ds_read_b128 v[80:83], v13 offset:16384
    ds_read_b64_tr_b16 v[84:85], v11 offset:2048
    ds_read_b64_tr_b16 v[86:87], v11 offset:2560
    ds_read_b64_tr_b16 v[88:89], v11 offset:10240
    ds_read_b64_tr_b16 v[90:91], v11 offset:10752
    ds_read_b64_tr_b16 v[92:93], v11 offset:18432
    ds_read_b64_tr_b16 v[94:95], v11 offset:18944
    s_waitcnt lgkmcnt(7)
    v_mfma_f32_32x32x16_bf16 v[16:31], v[68:71], v[64:67], v[16:31]
    v_mfma_f32_32x32x16_bf16 v[32:47], v[72:75], v[64:67], v[32:47]
    v_mfma_f32_32x32x16_bf16 v[48:63], v[64:67], v[76:79], v[48:63]
    ds_read_b128 v[64:67], v14 offset:16384
    ds_read_b64_tr_b16 v[68:69], v11 offset:4096
    ds_read_b64_tr_b16 v[70:71], v11 offset:4608
    ds_read_b64_tr_b16 v[72:73], v11 offset:12288
    ds_read_b64_tr_b16 v[74:75], v11 offset:12800
    ds_read_b64_tr_b16 v[76:77], v11 offset:20480
    ds_read_b64_tr_b16 v[78:79], v11 offset:20992
    s_waitcnt lgkmcnt(7)
    v_mfma_f32_32x32x16_bf16 v[16:31], v[84:87], v[80:83], v[16:31]
    v_mfma_f32_32x32x16_bf16 v[32:47], v[88:91], v[80:83], v[32:47]
    v_mfma_f32_32x32x16_bf16 v[48:63], v[80:83], v[92:95], v[48:63]
    ds_read_b128 v[80:83], v15 offset:16384
    ds_read_b64_tr_b16 v[84:85], v11 offset:6144
    ds_read_b64_tr_b16 v[86:87], v11 offset:6656
    ds_read_b64_tr_b16 v[88:89], v11 offset:14336
    ds_read_b64_tr_b16 v[90:91], v11 offset:14848
    ds_read_b64_tr_b16 v[92:93], v11 offset:22528
    ds_read_b64_tr_b16 v[94:95], v11 offset:23040
    s_waitcnt lgkmcnt(7)
    v_mfma_f32_32x32x16_bf16 v[16:31], v[68:71], v[64:67], v[16:31]
    v_mfma_f32_32x32x16_bf16 v[32:47], v[72:75], v[64:67], v[32:47]
    v_mfma_f32_32x32x16_bf16 v[48:63], v[64:67], v[76:79], v[48:63]
    s_waitcnt lgkmcnt(0)
    v_mfma_f32_32x32x16_bf16 v[16:31], v[84:87], v[80:83], v[16:31]
    v_mfma_f32_32x32x16_bf16 v[32:47], v[88:91], v[80:83], v[32:47]
    v_mfma_f32_32x32x16_bf16 v[48:63], v[80:83], v[92:95], v[48:63]
    s_barrier
    ds_read_b128 v[64:67], v12 offset:24576
    ds_read_b64_tr_b16 v[68:69], v11 offset:24576
    ds_read_b64_tr_b16 v[70:71], v11 offset:25088
    ds_read_b64_tr_b16 v[72:73], v11 offset:32768
    ds_read_b64_tr_b16 v[74:75], v11 offset:33280
    ds_read_b64_tr_b16 v[76:77], v11 offset:40960
    ds_read_b64_tr_b16 v[78:79], v11 offset:41472
    ds_read_b128 v[80:83], v13 offset:24576
    ds_read_b64_tr_b16 v[84:85], v11 offset:26624
    ds_read_b64_tr_b16 v[86:87], v11 offset:27136
    ds_read_b64_tr_b16 v[88:89], v11 offset:34816
    ds_read_b64_tr_b16 v[90:91], v11 offset:35328
    ds_read_b64_tr_b16 v[92:93], v11 offset:43008
    ds_read_b64_tr_b16 v[94:95], v11 offset:43520
    s_waitcnt lgkmcnt(7)
    v_mfma_f32_32x32x16_bf16 v[16:31], v[68:71], v[64:67], v[16:31]
    v_mfma_f32_32x32x16_bf16 v[32:47], v[72:75], v[64:67], v[32:47]
    v_mfma_f32_32x32x16_bf16 v[48:63], v[64:67], v[76:79], v[48:63]
    ds_read_b128 v[64:67], v14 offset:24576
    ds_read_b64_tr_b16 v[68:69], v11 offset:28672
    ds_read_b64_tr_b16 v[70:71], v11 offset:29184
    ds_read_b64_tr_b16 v[72:73], v11 offset:36864
    ds_read_b64_tr_b16 v[74:75], v11 offset:37376
    ds_read_b64_tr_b16 v[76:77], v11 offset:45056
    ds_read_b64_tr_b16 v[78:79], v11 offset:45568
    s_waitcnt lgkmcnt(7)
    v_mfma_f32_32x32x16_bf16 v[16:31], v[84:87], v[80:83], v[16:31]
    v_mfma_f32_32x32x16_bf16 v[32:47], v[88:91], v[80:83], v[32:47]
    v_mfma_f32_32x32x16_bf16 v[48:63], v[80:83], v[92:95], v[48:63]
    ds_read_b128 v[80:83], v15 offset:24576
    ds_read_b64_tr_b16 v[84:85], v11 offset:30720
    ds_read_b64_tr_b16 v[86:87], v11 offset:31232
    ds_read_b64_tr_b16 v[88:89], v11 offset:38912
    ds_read_b64_tr_b16 v[90:91], v11 offset:39424
    ds_read_b64_tr_b16 v[92:93], v11 offset:47104
    ds_read_b64_tr_b16 v[94:95], v11 offset:47616
    s_waitcnt lgkmcnt(7)
    v_mfma_f32_32x32x16_bf16 v[16:31], v[68:71], v[64:67], v[16:31]
    v_mfma_f32_32x32x16_bf16 v[32:47], v[72:75], v[64:67], v[32:47]
    v_mfma_f32_32x32x16_bf16 v[48:63], v[64:67], v[76:79], v[48:63]
    s_waitcnt lgkmcnt(0)
    v_mfma_f32_32x32x16_bf16 v[16:31], v[84:87], v[80:83], v[16:31]
    v_mfma_f32_32x32x16_bf16 v[32:47], v[88:91], v[80:83], v[32:47]
    v_mfma_f32_32x32x16_bf16 v[48:63], v[80:83], v[92:95], v[48:63]
    s_nop 7
    s_nop 3
    v_cvt_pk_bf16_f32 v64, v16, v17
    v_cvt_pk_bf16_f32 v65, v18, v19
    v_cvt_pk_bf16_f32 v66, v20, v21
    v_cvt_pk_bf16_f32 v67, v22, v23
    buffer_store_dwordx4 v[64:67], v5, s[20:23], s31 offen sc1
    v_cvt_pk_bf16_f32 v68, v24, v25
    v_cvt_pk_bf16_f32 v69, v26, v27
    v_cvt_pk_bf16_f32 v70, v28, v29
    v_cvt_pk_bf16_f32 v71, v30, v31
    buffer_store_dwordx4 v[68:71], v5, s[20:23], s32 offen sc1
    v_cvt_pk_bf16_f32 v72, v32, v33
    v_cvt_pk_bf16_f32 v73, v34, v35
    v_cvt_pk_bf16_f32 v74, v36, v37
    v_cvt_pk_bf16_f32 v75, v38, v39
    buffer_store_dwordx4 v[72:75], v5, s[20:23], s33 offen sc1
    v_cvt_pk_bf16_f32 v76, v40, v41
    v_cvt_pk_bf16_f32 v77, v42, v43
    v_cvt_pk_bf16_f32 v78, v44, v45
    v_cvt_pk_bf16_f32 v79, v46, v47
    buffer_store_dwordx4 v[76:79], v5, s[20:23], s34 offen sc1
    v_cvt_pk_bf16_f32 v80, v48, v49
    v_cvt_pk_bf16_f32 v81, v50, v51
    v_cvt_pk_bf16_f32 v82, v52, v53
    v_cvt_pk_bf16_f32 v83, v54, v55
    buffer_store_dwordx4 v[80:83], v6, s[20:23], s35 offen offset:0 sc1
    v_cvt_pk_bf16_f32 v84, v56, v57
    v_cvt_pk_bf16_f32 v85, v58, v59
    v_cvt_pk_bf16_f32 v86, v60, v61
    v_cvt_pk_bf16_f32 v87, v62, v63
    buffer_store_dwordx4 v[84:87], v6, s[20:23], s35 offen offset:512 sc1
    s_endpgm
K1_END:
    s_endpgm
.globl attn_kernel
.p2align 8
.type attn_kernel,@function
attn_kernel:
    s_cmp_ge_u32 s2, 256
    s_cbranch_scc1 K2_END
    s_load_dwordx2 s[8:9], s[0:1], 40
    s_load_dwordx2 s[10:11], s[0:1], 16
    v_lshrrev_b32 v2, 6, v0
    v_and_b32 v1, 63, v0
    s_and_b32 s50, s2, 7
    s_lshl_b32 s50, s50, 2
    s_bfe_u32 s51, s2, 0x20003
    s_add_u32 s50, s50, s51
    v_readfirstlane_b32 s52, v2
    s_lshr_b32 s51, s2, 5
    v_and_b32 v3, 31, v1
    v_lshrrev_b32 v4, 5, v1
    v_lshlrev_b32 v5, 5, v3
    v_lshl_add_u32 v5, v4, 4, v5
    v_lshlrev_b32 v2, 4, v1
    s_mul_i32 s53, s50, 196608
    s_lshl_b32 s56, s51, 3
    s_add_u32 s51, s56, s52
    s_lshl_b32 s54, s51, 10
    s_add_u32 s54, s54, s53
    s_lshl_b32 s57, s52, 1
    s_add_u32 s58, s56, s57
    s_sub_i32 s58, s58, 8
    s_add_i32 s59, s58, 1
    s_max_i32 s58, s58, 0
    s_max_i32 s59, s59, 0
    s_lshl_b32 s58, s58, 10
    s_lshl_b32 s59, s59, 10
    s_add_u32 s58, s58, s53
    s_add_u32 s59, s59, s53
    s_lshl_b32 s57, s57, 10
    s_lshl_b32 s60, s52, 10
    v_add_u32 v6, s60, v5
    s_waitcnt lgkmcnt(0)
    s_mov_b32 s12, s8
    s_and_b32 s13, s9, 0xffff
    s_mov_b32 s14, 0x800000
    s_mov_b32 s15, 0x00020000
    s_add_u32 s61, s58, 65536
    s_add_u32 m0, s57, 0
    s_nop 0
    buffer_load_dwordx4 v2, s[12:15], s61 offen lds
    s_add_u32 s61, s59, 65536
    s_add_u32 m0, s57, 1024
    s_nop 0
    buffer_load_dwordx4 v2, s[12:15], s61 offen lds
    buffer_load_dwordx4 v[8:11], v5, s[12:15], s54 offen
    s_add_u32 s61, s58, 131072
    s_add_u32 m0, s57, 16384
    s_nop 0
    buffer_load_dwordx4 v2, s[12:15], s61 offen lds
    s_add_u32 s61, s59, 131072
    s_add_u32 m0, s57, 17408
    s_nop 0
    buffer_load_dwordx4 v2, s[12:15], s61 offen lds
    s_lshl_b32 s55, s51, 5
    s_add_u32 s55, s55, s50
    s_lshl_b32 s55, s55, 10
    s_add_u32 s55, s55, 6291456
    s_mov_b32 s64, s10
    s_and_b32 s65, s11, 0xffff
    s_mov_b32 s66, 0x80000
    s_mov_b32 s67, 0x00020000
    s_lshr_b32 s68, s2, 3
    s_lshl_b32 s68, s68, 4
    s_lshl_b32 s69, s52, 1
    s_add_u32 s68, s68, s69
    s_lshl_b32 s68, s68, 10
    s_and_b32 s69, s2, 1
    s_lshl_b32 s69, s69, 9
    s_add_u32 s68, s68, s69
    v_lshlrev_b32 v7, 4, v3
    v_lshl_add_u32 v7, v4, 10, v7
    buffer_load_dwordx4 v[252:255], v7, s[64:67], s68 offen
    v_lshrrev_b32 v7, 3, v3
    v_lshlrev_b32 v7, 1, v7
    v_bfe_u32 v2, v3, 1, 1
    v_add_u32 v7, v7, v2
    v_bfe_u32 v2, v3, 2, 1
    v_xor_b32 v2, v2, v4
    v_lshl_add_u32 v7, v2, 6, v7
    v_and_b32 v2, 1, v3
    v_lshlrev_b32 v2, 4, v2
    v_mov_b32 v52, 0x3eb9
    v_mov_b32 v53, 0xba2c
    v_lshlrev_b32 v52, v2, v52
    v_lshlrev_b32 v53, v2, v53
    v_cmp_eq_u32 s[16:17], 0, v7
    v_cmp_eq_u32 s[18:19], 1, v7
    v_cmp_eq_u32 s[20:21], 2, v7
    v_cmp_eq_u32 s[22:23], 3, v7
    v_cmp_eq_u32 s[24:25], 4, v7
    v_cmp_eq_u32 s[26:27], 5, v7
    v_cmp_eq_u32 s[28:29], 6, v7
    v_cmp_eq_u32 s[30:31], 7, v7
    s_nop 1
    v_cndmask_b32 v20, 0, v52, s[16:17]
    v_cndmask_b32 v28, 0, v53, s[16:17]
    v_cndmask_b32 v21, 0, v52, s[18:19]
    v_cndmask_b32 v29, 0, v53, s[18:19]
    v_cndmask_b32 v22, 0, v52, s[20:21]
    v_cndmask_b32 v30, 0, v53, s[20:21]
    v_cndmask_b32 v23, 0, v52, s[22:23]
    v_cndmask_b32 v31, 0, v53, s[22:23]
    v_cndmask_b32 v24, 0, v52, s[24:25]
    v_cndmask_b32 v32, 0, v53, s[24:25]
    v_cndmask_b32 v25, 0, v52, s[26:27]
    v_cndmask_b32 v33, 0, v53, s[26:27]
    v_cndmask_b32 v26, 0, v52, s[28:29]
    v_cndmask_b32 v34, 0, v53, s[28:29]
    v_cndmask_b32 v27, 0, v52, s[30:31]
    v_cndmask_b32 v35, 0, v53, s[30:31]
    v_lshlrev_b32 v7, 2, v4
    v_sub_u32 v7, v3, v7
    v_cmp_le_i32 s[16:17], 0, v7
    v_cmp_le_i32 s[18:19], 1, v7
    v_cmp_le_i32 s[20:21], 2, v7
    v_cmp_le_i32 s[22:23], 3, v7
    v_cmp_le_i32 s[24:25], 8, v7
    v_cmp_le_i32 s[26:27], 9, v7
    v_cmp_le_i32 s[28:29], 10, v7
    v_cmp_le_i32 s[30:31], 11, v7
    v_cmp_le_i32 s[32:33], 16, v7
    v_cmp_le_i32 s[34:35], 17, v7
    v_cmp_le_i32 s[36:37], 18, v7
    v_cmp_le_i32 s[38:39], 19, v7
    v_cmp_le_i32 s[40:41], 24, v7
    v_cmp_le_i32 s[42:43], 25, v7
    v_cmp_le_i32 s[44:45], 26, v7
    v_cmp_le_i32 s[46:47], 27, v7
    v_mov_b32 v3, 0xffff
    v_mov_b32 v7, 0xffff0000
    s_nop 1
    v_cndmask_b32 v12, 0, v3, s[16:17]
    v_cndmask_b32 v216, 0, v7, s[18:19]
    v_cndmask_b32 v13, 0, v3, s[20:21]
    v_cndmask_b32 v217, 0, v7, s[22:23]
    v_cndmask_b32 v14, 0, v3, s[24:25]
    v_cndmask_b32 v218, 0, v7, s[26:27]
    v_cndmask_b32 v15, 0, v3, s[28:29]
    v_cndmask_b32 v219, 0, v7, s[30:31]
    v_cndmask_b32 v16, 0, v3, s[32:33]
    v_cndmask_b32 v220, 0, v7, s[34:35]
    v_cndmask_b32 v17, 0, v3, s[36:37]
    v_cndmask_b32 v221, 0, v7, s[38:39]
    v_cndmask_b32 v18, 0, v3, s[40:41]
    v_cndmask_b32 v222, 0, v7, s[42:43]
    v_cndmask_b32 v19, 0, v3, s[44:45]
    v_cndmask_b32 v223, 0, v7, s[46:47]
    v_or_b32 v12, v12, v216
    v_or_b32 v13, v13, v217
    v_or_b32 v14, v14, v218
    v_or_b32 v15, v15, v219
    v_or_b32 v16, v16, v220
    v_or_b32 v17, v17, v221
    v_or_b32 v18, v18, v222
    v_or_b32 v19, v19, v223
    v_mov_b32 v36, 0
    v_mov_b32 v37, 0
    v_mov_b32 v38, 0
    v_mov_b32 v39, 0
    v_mov_b32 v40, 0
    v_mov_b32 v41, 0
    v_mov_b32 v42, 0
    v_mov_b32 v43, 0
    v_mov_b32 v44, 0
    v_mov_b32 v45, 0
    v_mov_b32 v46, 0
    v_mov_b32 v47, 0
    v_mov_b32 v48, 0
    v_mov_b32 v49, 0
    v_mov_b32 v50, 0
    v_mov_b32 v51, 0
    v_mov_b32 v3, 0xff800000
    v_mov_b32 v7, 0xff800000
    v_mov_b32 v4, 0x3f803f80
    s_waitcnt vmcnt(3)
    s_barrier
    ds_read_b128 v[180:183], v6 offset:0
    ds_read_b128 v[212:215], v6 offset:8192
    ds_read_b128 v[184:187], v6 offset:1024
    ds_read_b128 v[188:191], v6 offset:2048
    ds_read_b128 v[192:195], v6 offset:3072
    ds_read_b128 v[196:199], v6 offset:4096
    ds_read_b128 v[200:203], v6 offset:5120
    ds_read_b128 v[204:207], v6 offset:6144
    ds_read_b128 v[208:211], v6 offset:7168
    s_waitcnt lgkmcnt(8)
    v_mfma_f32_32x32x16_bf16 v[132:147], v[180:183], v[8:11], 0
    s_waitcnt lgkmcnt(7)
    v_mfma_f32_32x32x16_bf16 v[148:163], v[212:215], v[8:11], 0
    s_waitcnt lgkmcnt(6)
    v_mfma_f32_32x32x16_bf16 v[164:179], v[184:187], v[8:11], 0
    s_nop 7
    s_nop 1
    s_cmp_ge_u32 s51, 8
    s_cbranch_scc1 K2_HAVE0
    v_mov_b32 v132, 0xf14a0000
    v_mov_b32 v133, 0xf14a0000
    v_mov_b32 v134, 0xf14a0000
    v_mov_b32 v135, 0xf14a0000
    v_mov_b32 v136, 0xf14a0000
    v_mov_b32 v137, 0xf14a0000
    v_mov_b32 v138, 0xf14a0000
    v_mov_b32 v139, 0xf14a0000
    v_mov_b32 v140, 0xf14a0000
    v_mov_b32 v141, 0xf14a0000
    v_mov_b32 v142, 0xf14a0000
    v_mov_b32 v143, 0xf14a0000
    v_mov_b32 v144, 0xf14a0000
    v_mov_b32 v145, 0xf14a0000
    v_mov_b32 v146, 0xf14a0000
    v_mov_b32 v147, 0xf14a0000
K2_HAVE0:
    v_cndmask_b32 v148, v132, v148, s[16:17]
    v_cndmask_b32 v149, v133, v149, s[18:19]
    v_cndmask_b32 v150, v134, v150, s[20:21]
    v_cndmask_b32 v151, v135, v151, s[22:23]
    v_cndmask_b32 v152, v136, v152, s[24:25]
    v_cndmask_b32 v153, v137, v153, s[26:27]
    v_cndmask_b32 v154, v138, v154, s[28:29]
    v_cndmask_b32 v155, v139, v155, s[30:31]
    v_cndmask_b32 v156, v140, v156, s[32:33]
    v_cndmask_b32 v157, v141, v157, s[34:35]
    v_cndmask_b32 v158, v142, v158, s[36:37]
    v_cndmask_b32 v159, v143, v159, s[38:39]
    v_cndmask_b32 v160, v144, v160, s[40:41]
    v_cndmask_b32 v161, v145, v161, s[42:43]
    v_cndmask_b32 v162, v146, v162, s[44:45]
    v_cndmask_b32 v163, v147, v163, s[46:47]
    s_waitcnt lgkmcnt(5)
    v_mfma_f32_32x32x16_bf16 v[132:147], v[188:191], v[8:11], 0
    v_max3_f32 v3, v3, v148, v149
    v_cvt_pk_bf16_f32 v68, v148, v149
    v_max3_f32 v7, v7, v150, v151
    v_cvt_pk_bf16_f32 v69, v150, v151
    v_max3_f32 v3, v3, v152, v153
    v_cvt_pk_bf16_f32 v70, v152, v153
    v_max3_f32 v7, v7, v154, v155
    v_cvt_pk_bf16_f32 v71, v154, v155
    v_max3_f32 v3, v3, v156, v157
    v_cvt_pk_bf16_f32 v72, v156, v157
    v_max3_f32 v7, v7, v158, v159
    v_cvt_pk_bf16_f32 v73, v158, v159
    v_max3_f32 v3, v3, v160, v161
    v_cvt_pk_bf16_f32 v74, v160, v161
    v_max3_f32 v7, v7, v162, v163
    v_cvt_pk_bf16_f32 v75, v162, v163
    s_waitcnt lgkmcnt(4)
    v_mfma_f32_32x32x16_bf16 v[148:163], v[192:195], v[8:11], 0
    s_cmp_ge_u32 s51, 7
    s_cbranch_scc1 K2_T1_OK
    v_mov_b32 v76, 0xf14af14a
    v_mov_b32 v77, 0xf14af14a
    v_mov_b32 v78, 0xf14af14a
    v_mov_b32 v79, 0xf14af14a
    v_mov_b32 v80, 0xf14af14a
    v_mov_b32 v81, 0xf14af14a
    v_mov_b32 v82, 0xf14af14a
    v_mov_b32 v83, 0xf14af14a
    s_nop 3
    s_branch K2_T1_DONE
K2_T1_OK:
    v_max3_f32 v3, v3, v164, v165
    v_cvt_pk_bf16_f32 v76, v164, v165
    v_max3_f32 v7, v7, v166, v167
    v_cvt_pk_bf16_f32 v77, v166, v167
    v_max3_f32 v3, v3, v168, v169
    v_cvt_pk_bf16_f32 v78, v168, v169
    v_max3_f32 v7, v7, v170, v171
    v_cvt_pk_bf16_f32 v79, v170, v171
    v_max3_f32 v3, v3, v172, v173
    v_cvt_pk_bf16_f32 v80, v172, v173
    v_max3_f32 v7, v7, v174, v175
    v_cvt_pk_bf16_f32 v81, v174, v175
    v_max3_f32 v3, v3, v176, v177
    v_cvt_pk_bf16_f32 v82, v176, v177
    v_max3_f32 v7, v7, v178, v179
    v_cvt_pk_bf16_f32 v83, v178, v179
K2_T1_DONE:
    s_waitcnt lgkmcnt(3)
    v_mfma_f32_32x32x16_bf16 v[164:179], v[196:199], v[8:11], 0
    s_cmp_ge_u32 s51, 6
    s_cbranch_scc1 K2_T2_OK
    v_mov_b32 v84, 0xf14af14a
    v_mov_b32 v85, 0xf14af14a
    v_mov_b32 v86, 0xf14af14a
    v_mov_b32 v87, 0xf14af14a
    v_mov_b32 v88, 0xf14af14a
    v_mov_b32 v89, 0xf14af14a
    v_mov_b32 v90, 0xf14af14a
    v_mov_b32 v91, 0xf14af14a
    s_nop 3
    s_branch K2_T2_DONE
K2_T2_OK:
    v_max3_f32 v3, v3, v132, v133
    v_cvt_pk_bf16_f32 v84, v132, v133
    v_max3_f32 v7, v7, v134, v135
    v_cvt_pk_bf16_f32 v85, v134, v135
    v_max3_f32 v3, v3, v136, v137
    v_cvt_pk_bf16_f32 v86, v136, v137
    v_max3_f32 v7, v7, v138, v139
    v_cvt_pk_bf16_f32 v87, v138, v139
    v_max3_f32 v3, v3, v140, v141
    v_cvt_pk_bf16_f32 v88, v140, v141
    v_max3_f32 v7, v7, v142, v143
    v_cvt_pk_bf16_f32 v89, v142, v143
    v_max3_f32 v3, v3, v144, v145
    v_cvt_pk_bf16_f32 v90, v144, v145
    v_max3_f32 v7, v7, v146, v147
    v_cvt_pk_bf16_f32 v91, v146, v147
K2_T2_DONE:
    s_waitcnt lgkmcnt(2)
    v_mfma_f32_32x32x16_bf16 v[132:147], v[200:203], v[8:11], 0
    s_cmp_ge_u32 s51, 5
    s_cbranch_scc1 K2_T3_OK
    v_mov_b32 v92, 0xf14af14a
    v_mov_b32 v93, 0xf14af14a
    v_mov_b32 v94, 0xf14af14a
    v_mov_b32 v95, 0xf14af14a
    v_mov_b32 v96, 0xf14af14a
    v_mov_b32 v97, 0xf14af14a
    v_mov_b32 v98, 0xf14af14a
    v_mov_b32 v99, 0xf14af14a
    s_nop 3
    s_branch K2_T3_DONE
K2_T3_OK:
    v_max3_f32 v3, v3, v148, v149
    v_cvt_pk_bf16_f32 v92, v148, v149
    v_max3_f32 v7, v7, v150, v151
    v_cvt_pk_bf16_f32 v93, v150, v151
    v_max3_f32 v3, v3, v152, v153
    v_cvt_pk_bf16_f32 v94, v152, v153
    v_max3_f32 v7, v7, v154, v155
    v_cvt_pk_bf16_f32 v95, v154, v155
    v_max3_f32 v3, v3, v156, v157
    v_cvt_pk_bf16_f32 v96, v156, v157
    v_max3_f32 v7, v7, v158, v159
    v_cvt_pk_bf16_f32 v97, v158, v159
    v_max3_f32 v3, v3, v160, v161
    v_cvt_pk_bf16_f32 v98, v160, v161
    v_max3_f32 v7, v7, v162, v163
    v_cvt_pk_bf16_f32 v99, v162, v163
K2_T3_DONE:
    s_waitcnt lgkmcnt(1)
    v_mfma_f32_32x32x16_bf16 v[148:163], v[204:207], v[8:11], 0
    s_cmp_ge_u32 s51, 4
    s_cbranch_scc1 K2_T4_OK
    v_mov_b32 v100, 0xf14af14a
    v_mov_b32 v101, 0xf14af14a
    v_mov_b32 v102, 0xf14af14a
    v_mov_b32 v103, 0xf14af14a
    v_mov_b32 v104, 0xf14af14a
    v_mov_b32 v105, 0xf14af14a
    v_mov_b32 v106, 0xf14af14a
    v_mov_b32 v107, 0xf14af14a
    s_nop 3
    s_branch K2_T4_DONE
K2_T4_OK:
    v_max3_f32 v3, v3, v164, v165
    v_cvt_pk_bf16_f32 v100, v164, v165
    v_max3_f32 v7, v7, v166, v167
    v_cvt_pk_bf16_f32 v101, v166, v167
    v_max3_f32 v3, v3, v168, v169
    v_cvt_pk_bf16_f32 v102, v168, v169
    v_max3_f32 v7, v7, v170, v171
    v_cvt_pk_bf16_f32 v103, v170, v171
    v_max3_f32 v3, v3, v172, v173
    v_cvt_pk_bf16_f32 v104, v172, v173
    v_max3_f32 v7, v7, v174, v175
    v_cvt_pk_bf16_f32 v105, v174, v175
    v_max3_f32 v3, v3, v176, v177
    v_cvt_pk_bf16_f32 v106, v176, v177
    v_max3_f32 v7, v7, v178, v179
    v_cvt_pk_bf16_f32 v107, v178, v179
K2_T4_DONE:
    s_waitcnt lgkmcnt(0)
    v_mfma_f32_32x32x16_bf16 v[164:179], v[208:211], v[8:11], 0
    v_mov_b32 v180, v4
    v_mov_b32 v181, v4
    v_mov_b32 v182, v4
    v_mov_b32 v183, v4
    v_mov_b32 v184, v4
    v_mov_b32 v185, v4
    v_mov_b32 v186, v4
    v_mov_b32 v187, v4
    v_mov_b32 v188, v4
    v_mov_b32 v189, v4
    v_mov_b32 v190, v4
    v_mov_b32 v191, v4
    v_mov_b32 v192, v4
    v_mov_b32 v193, v4
    v_mov_b32 v194, v4
    v_mov_b32 v195, v4
    s_waitcnt vmcnt(1)
    s_barrier
    s_mov_b32 exec_lo, 0xffff
    s_mov_b32 exec_hi, 0xffff
    ds_read_b128 v[180:183], v6 offset:24576
    ds_read_b128 v[184:187], v6 offset:25088
    ds_read_b128 v[188:191], v6 offset:16384
    ds_read_b128 v[192:195], v6 offset:16896
    s_mov_b64 exec, -1
    s_cmp_ge_u32 s51, 3
    s_cbranch_scc1 K2_T5_OK
    v_mov_b32 v108, 0xf14af14a
    v_mov_b32 v109, 0xf14af14a
    v_mov_b32 v110, 0xf14af14a
    v_mov_b32 v111, 0xf14af14a
    v_mov_b32 v112, 0xf14af14a
    v_mov_b32 v113, 0xf14af14a
    v_mov_b32 v114, 0xf14af14a
    v_mov_b32 v115, 0xf14af14a
    s_nop 3
    s_branch K2_T5_DONE
K2_T5_OK:
    v_max3_f32 v3, v3, v132, v133
    v_cvt_pk_bf16_f32 v108, v132, v133
    v_max3_f32 v7, v7, v134, v135
    v_cvt_pk_bf16_f32 v109, v134, v135
    v_max3_f32 v3, v3, v136, v137
    v_cvt_pk_bf16_f32 v110, v136, v137
    v_max3_f32 v7, v7, v138, v139
    v_cvt_pk_bf16_f32 v111, v138, v139
    v_max3_f32 v3, v3, v140, v141
    v_cvt_pk_bf16_f32 v112, v140, v141
    v_max3_f32 v7, v7, v142, v143
    v_cvt_pk_bf16_f32 v113, v142, v143
    v_max3_f32 v3, v3, v144, v145
    v_cvt_pk_bf16_f32 v114, v144, v145
    v_max3_f32 v7, v7, v146, v147
    v_cvt_pk_bf16_f32 v115, v146, v147
K2_T5_DONE:
    v_mov_b32 v196, v4
    v_mov_b32 v197, v4
    v_mov_b32 v198, v4
    v_mov_b32 v199, v4
    v_mov_b32 v200, v4
    v_mov_b32 v201, v4
    v_mov_b32 v202, v4
    v_mov_b32 v203, v4
    v_mov_b32 v204, v4
    v_mov_b32 v205, v4
    v_mov_b32 v206, v4
    v_mov_b32 v207, v4
    v_mov_b32 v208, v4
    v_mov_b32 v209, v4
    v_mov_b32 v210, v4
    v_mov_b32 v211, v4
    s_mov_b32 exec_lo, 0xffff
    s_mov_b32 exec_hi, 0xffff
    ds_read_b128 v[196:199], v6 offset:17408
    ds_read_b128 v[200:203], v6 offset:17920
    ds_read_b128 v[204:207], v6 offset:18432
    ds_read_b128 v[208:211], v6 offset:18944
    s_mov_b64 exec, -1
    s_cmp_ge_u32 s51, 2
    s_cbranch_scc1 K2_T6_OK
    v_mov_b32 v116, 0xf14af14a
    v_mov_b32 v117, 0xf14af14a
    v_mov_b32 v118, 0xf14af14a
    v_mov_b32 v119, 0xf14af14a
    v_mov_b32 v120, 0xf14af14a
    v_mov_b32 v121, 0xf14af14a
    v_mov_b32 v122, 0xf14af14a
    v_mov_b32 v123, 0xf14af14a
    s_nop 3
    s_branch K2_T6_DONE
K2_T6_OK:
    v_max3_f32 v3, v3, v148, v149
    v_cvt_pk_bf16_f32 v116, v148, v149
    v_max3_f32 v7, v7, v150, v151
    v_cvt_pk_bf16_f32 v117, v150, v151
    v_max3_f32 v3, v3, v152, v153
    v_cvt_pk_bf16_f32 v118, v152, v153
    v_max3_f32 v7, v7, v154, v155
    v_cvt_pk_bf16_f32 v119, v154, v155
    v_max3_f32 v3, v3, v156, v157
    v_cvt_pk_bf16_f32 v120, v156, v157
    v_max3_f32 v7, v7, v158, v159
    v_cvt_pk_bf16_f32 v121, v158, v159
    v_max3_f32 v3, v3, v160, v161
    v_cvt_pk_bf16_f32 v122, v160, v161
    v_max3_f32 v7, v7, v162, v163
    v_cvt_pk_bf16_f32 v123, v162, v163
K2_T6_DONE:
    s_cmp_ge_u32 s51, 1
    s_cbranch_scc1 K2_T7_OK
    v_mov_b32 v124, 0xf14af14a
    v_mov_b32 v125, 0xf14af14a
    v_mov_b32 v126, 0xf14af14a
    v_mov_b32 v127, 0xf14af14a
    v_mov_b32 v128, 0xf14af14a
    v_mov_b32 v129, 0xf14af14a
    v_mov_b32 v130, 0xf14af14a
    v_mov_b32 v131, 0xf14af14a
    s_nop 3
    s_branch K2_T7_DONE
K2_T7_OK:
    v_max3_f32 v3, v3, v164, v165
    v_cvt_pk_bf16_f32 v124, v164, v165
    v_max3_f32 v7, v7, v166, v167
    v_cvt_pk_bf16_f32 v125, v166, v167
    v_max3_f32 v3, v3, v168, v169
    v_cvt_pk_bf16_f32 v126, v168, v169
    v_max3_f32 v7, v7, v170, v171
    v_cvt_pk_bf16_f32 v127, v170, v171
    v_max3_f32 v3, v3, v172, v173
    v_cvt_pk_bf16_f32 v128, v172, v173
    v_max3_f32 v7, v7, v174, v175
    v_cvt_pk_bf16_f32 v129, v174, v175
    v_max3_f32 v3, v3, v176, v177
    v_cvt_pk_bf16_f32 v130, v176, v177
    v_max3_f32 v7, v7, v178, v179
    v_cvt_pk_bf16_f32 v131, v178, v179
K2_T7_DONE:
    v_max_f32 v3, v3, v7
    v_mov_b32 v7, v3
    s_nop 1
    v_permlane32_swap_b32 v3, v7
    s_nop 1
    v_max_f32 v3, v3, v7
    v_cvt_pk_bf16_f32 v3, 0, v3
    v_mul_f32 v3, 0xbeb8aa00, v3
    v_mov_b32 v52, v3
    v_mov_b32 v53, v3
    v_mov_b32 v54, v3
    v_mov_b32 v55, v3
    v_mov_b32 v56, v3
    v_mov_b32 v57, v3
    v_mov_b32 v58, v3
    v_mov_b32 v59, v3
    v_mov_b32 v60, v3
    v_mov_b32 v61, v3
    v_mov_b32 v62, v3
    v_mov_b32 v63, v3
    v_mov_b32 v64, v3
    v_mov_b32 v65, v3
    v_mov_b32 v66, v3
    v_mov_b32 v67, v3
    s_nop 1
    v_mfma_f32_32x32x16_bf16 v[132:147], v[20:23], v[68:71], v[52:67]
    v_mfma_f32_32x32x16_bf16 v[132:147], v[24:27], v[72:75], v[132:147]
    v_mfma_f32_32x32x16_bf16 v[132:147], v[28:31], v[68:71], v[132:147]
    v_mfma_f32_32x32x16_bf16 v[132:147], v[32:35], v[72:75], v[132:147]
    s_nop 7
    s_nop 3
    v_exp_f32 v132, v132
    v_exp_f32 v133, v133
    v_mfma_f32_32x32x16_bf16 v[148:163], v[20:23], v[76:79], v[52:67]
    v_exp_f32 v134, v134
    v_exp_f32 v135, v135
    v_exp_f32 v136, v136
    v_mfma_f32_32x32x16_bf16 v[148:163], v[24:27], v[80:83], v[148:163]
    v_exp_f32 v137, v137
    v_exp_f32 v138, v138
    v_exp_f32 v139, v139
    v_mfma_f32_32x32x16_bf16 v[148:163], v[28:31], v[76:79], v[148:163]
    v_exp_f32 v140, v140
    v_exp_f32 v141, v141
    v_exp_f32 v142, v142
    v_mfma_f32_32x32x16_bf16 v[148:163], v[32:35], v[80:83], v[148:163]
    v_exp_f32 v143, v143
    v_exp_f32 v144, v144
    v_exp_f32 v145, v145
    v_exp_f32 v146, v146
    v_exp_f32 v147, v147
    s_nop 0
    v_cvt_pk_bf16_f32 v216, v132, v133
    v_cvt_pk_bf16_f32 v217, v134, v135
    v_cvt_pk_bf16_f32 v218, v136, v137
    v_cvt_pk_bf16_f32 v219, v138, v139
    v_cvt_pk_bf16_f32 v220, v140, v141
    v_cvt_pk_bf16_f32 v221, v142, v143
    v_cvt_pk_bf16_f32 v222, v144, v145
    v_cvt_pk_bf16_f32 v223, v146, v147
    v_and_b32 v224, v216, v12
    v_bfi_b32 v232, v12, 0, v216
    v_and_b32 v225, v217, v13
    v_bfi_b32 v233, v13, 0, v217
    v_and_b32 v226, v218, v14
    v_bfi_b32 v234, v14, 0, v218
    v_and_b32 v227, v219, v15
    v_bfi_b32 v235, v15, 0, v219
    v_and_b32 v228, v220, v16
    v_bfi_b32 v236, v16, 0, v220
    v_and_b32 v229, v221, v17
    v_bfi_b32 v237, v17, 0, v221
    v_and_b32 v230, v222, v18
    v_bfi_b32 v238, v18, 0, v222
    v_and_b32 v231, v223, v19
    v_bfi_b32 v239, v19, 0, v223
    v_exp_f32 v148, v148
    v_exp_f32 v149, v149
    v_mfma_f32_32x32x16_bf16 v[132:147], v[20:23], v[84:87], v[52:67]
    v_exp_f32 v150, v150
    v_exp_f32 v151, v151
    v_mfma_f32_32x32x16_bf16 v[132:147], v[24:27], v[88:91], v[132:147]
    v_exp_f32 v152, v152
    v_exp_f32 v153, v153
    v_mfma_f32_32x32x16_bf16 v[132:147], v[28:31], v[84:87], v[132:147]
    v_exp_f32 v154, v154
    v_exp_f32 v155, v155
    v_mfma_f32_32x32x16_bf16 v[132:147], v[32:35], v[88:91], v[132:147]
    v_exp_f32 v156, v156
    v_exp_f32 v157, v157
    s_waitcnt lgkmcnt(4)
    v_mfma_f32_32x32x16_bf16 v[36:51], v[180:183], v[224:227], v[36:51]
    v_exp_f32 v158, v158
    v_exp_f32 v159, v159
    v_mfma_f32_32x32x16_bf16 v[36:51], v[184:187], v[228:231], v[36:51]
    v_exp_f32 v160, v160
    v_exp_f32 v161, v161
    v_mfma_f32_32x32x16_bf16 v[36:51], v[188:191], v[232:235], v[36:51]
    v_exp_f32 v162, v162
    v_exp_f32 v163, v163
    v_mfma_f32_32x32x16_bf16 v[36:51], v[192:195], v[236:239], v[36:51]
    s_mov_b32 exec_lo, 0xffff
    s_mov_b32 exec_hi, 0xffff
    ds_read_b128 v[180:183], v6 offset:19456
    ds_read_b128 v[184:187], v6 offset:19968
    ds_read_b128 v[188:191], v6 offset:20480
    ds_read_b128 v[192:195], v6 offset:20992
    s_mov_b64 exec, -1
    s_nop 0
    v_cvt_pk_bf16_f32 v216, v148, v149
    v_cvt_pk_bf16_f32 v217, v150, v151
    v_cvt_pk_bf16_f32 v218, v152, v153
    v_cvt_pk_bf16_f32 v219, v154, v155
    v_cvt_pk_bf16_f32 v220, v156, v157
    v_cvt_pk_bf16_f32 v221, v158, v159
    v_cvt_pk_bf16_f32 v222, v160, v161
    v_cvt_pk_bf16_f32 v223, v162, v163
    v_exp_f32 v132, v132
    v_exp_f32 v133, v133
    v_mfma_f32_32x32x16_bf16 v[148:163], v[20:23], v[92:95], v[52:67]
    v_exp_f32 v134, v134
    v_exp_f32 v135, v135
    v_exp_f32 v136, v136
    v_mfma_f32_32x32x16_bf16 v[148:163], v[24:27], v[96:99], v[148:163]
    v_exp_f32 v137, v137
    v_exp_f32 v138, v138
    v_exp_f32 v139, v139
    v_mfma_f32_32x32x16_bf16 v[148:163], v[28:31], v[92:95], v[148:163]
    v_exp_f32 v140, v140
    v_exp_f32 v141, v141
    v_exp_f32 v142, v142
    v_mfma_f32_32x32x16_bf16 v[148:163], v[32:35], v[96:99], v[148:163]
    v_exp_f32 v143, v143
    v_exp_f32 v144, v144
    v_exp_f32 v145, v145
    s_waitcnt lgkmcnt(6)
    v_mfma_f32_32x32x16_bf16 v[36:51], v[196:199], v[216:219], v[36:51]
    v_exp_f32 v146, v146
    v_exp_f32 v147, v147
    s_nop 0
    v_mfma_f32_32x32x16_bf16 v[36:51], v[200:203], v[220:223], v[36:51]
    s_mov_b32 exec_lo, 0xffff
    s_mov_b32 exec_hi, 0xffff
    ds_read_b128 v[196:199], v6 offset:21504
    ds_read_b128 v[200:203], v6 offset:22016
    s_mov_b64 exec, -1
    v_cvt_pk_bf16_f32 v224, v132, v133
    v_cvt_pk_bf16_f32 v225, v134, v135
    v_cvt_pk_bf16_f32 v226, v136, v137
    v_cvt_pk_bf16_f32 v227, v138, v139
    v_cvt_pk_bf16_f32 v228, v140, v141
    v_cvt_pk_bf16_f32 v229, v142, v143
    v_cvt_pk_bf16_f32 v230, v144, v145
    v_cvt_pk_bf16_f32 v231, v146, v147
    v_exp_f32 v148, v148
    v_exp_f32 v149, v149
    v_mfma_f32_32x32x16_bf16 v[132:147], v[20:23], v[100:103], v[52:67]
    v_exp_f32 v150, v150
    v_exp_f32 v151, v151
    v_exp_f32 v152, v152
    v_mfma_f32_32x32x16_bf16 v[132:147], v[24:27], v[104:107], v[132:147]
    v_exp_f32 v153, v153
    v_exp_f32 v154, v154
    v_exp_f32 v155, v155
    v_mfma_f32_32x32x16_bf16 v[132:147], v[28:31], v[100:103], v[132:147]
    v_exp_f32 v156, v156
    v_exp_f32 v157, v157
    v_exp_f32 v158, v158
    v_mfma_f32_32x32x16_bf16 v[132:147], v[32:35], v[104:107], v[132:147]
    v_exp_f32 v159, v159
    v_exp_f32 v160, v160
    v_exp_f32 v161, v161
    s_waitcnt lgkmcnt(6)
    v_mfma_f32_32x32x16_bf16 v[36:51], v[204:207], v[224:227], v[36:51]
    v_exp_f32 v162, v162
    v_exp_f32 v163, v163
    s_nop 0
    v_mfma_f32_32x32x16_bf16 v[36:51], v[208:211], v[228:231], v[36:51]
    s_mov_b32 exec_lo, 0xffff
    s_mov_b32 exec_hi, 0xffff
    ds_read_b128 v[204:207], v6 offset:22528
    ds_read_b128 v[208:211], v6 offset:23040
    s_mov_b64 exec, -1
    v_cvt_pk_bf16_f32 v216, v148, v149
    v_cvt_pk_bf16_f32 v217, v150, v151
    v_cvt_pk_bf16_f32 v218, v152, v153
    v_cvt_pk_bf16_f32 v219, v154, v155
    v_cvt_pk_bf16_f32 v220, v156, v157
    v_cvt_pk_bf16_f32 v221, v158, v159
    v_cvt_pk_bf16_f32 v222, v160, v161
    v_cvt_pk_bf16_f32 v223, v162, v163
    v_exp_f32 v132, v132
    v_exp_f32 v133, v133
    v_mfma_f32_32x32x16_bf16 v[148:163], v[20:23], v[108:111], v[52:67]
    v_exp_f32 v134, v134
    v_exp_f32 v135, v135
    v_exp_f32 v136, v136
    v_mfma_f32_32x32x16_bf16 v[148:163], v[24:27], v[112:115], v[148:163]
    v_exp_f32 v137, v137
    v_exp_f32 v138, v138
    v_exp_f32 v139, v139
    v_mfma_f32_32x32x16_bf16 v[148:163], v[28:31], v[108:111], v[148:163]
    v_exp_f32 v140, v140
    v_exp_f32 v141, v141
    v_exp_f32 v142, v142
    v_mfma_f32_32x32x16_bf16 v[148:163], v[32:35], v[112:115], v[148:163]
    v_exp_f32 v143, v143
    v_exp_f32 v144, v144
    v_exp_f32 v145, v145
    s_waitcnt lgkmcnt(6)
    v_mfma_f32_32x32x16_bf16 v[36:51], v[180:183], v[216:219], v[36:51]
    v_exp_f32 v146, v146
    v_exp_f32 v147, v147
    s_nop 0
    v_mfma_f32_32x32x16_bf16 v[36:51], v[184:187], v[220:223], v[36:51]
    s_mov_b32 exec_lo, 0xffff
    s_mov_b32 exec_hi, 0xffff
    ds_read_b128 v[180:183], v6 offset:23552
    ds_read_b128 v[184:187], v6 offset:24064
    s_mov_b64 exec, -1
    v_cvt_pk_bf16_f32 v224, v132, v133
    v_cvt_pk_bf16_f32 v225, v134, v135
    v_cvt_pk_bf16_f32 v226, v136, v137
    v_cvt_pk_bf16_f32 v227, v138, v139
    v_cvt_pk_bf16_f32 v228, v140, v141
    v_cvt_pk_bf16_f32 v229, v142, v143
    v_cvt_pk_bf16_f32 v230, v144, v145
    v_cvt_pk_bf16_f32 v231, v146, v147
    v_exp_f32 v148, v148
    v_exp_f32 v149, v149
    v_mfma_f32_32x32x16_bf16 v[132:147], v[20:23], v[116:119], v[52:67]
    v_exp_f32 v150, v150
    v_exp_f32 v151, v151
    v_exp_f32 v152, v152
    v_mfma_f32_32x32x16_bf16 v[132:147], v[24:27], v[120:123], v[132:147]
    v_exp_f32 v153, v153
    v_exp_f32 v154, v154
    v_exp_f32 v155, v155
    v_mfma_f32_32x32x16_bf16 v[132:147], v[28:31], v[116:119], v[132:147]
    v_exp_f32 v156, v156
    v_exp_f32 v157, v157
    v_exp_f32 v158, v158
    v_mfma_f32_32x32x16_bf16 v[132:147], v[32:35], v[120:123], v[132:147]
    v_exp_f32 v159, v159
    v_exp_f32 v160, v160
    v_exp_f32 v161, v161
    s_waitcnt lgkmcnt(6)
    v_mfma_f32_32x32x16_bf16 v[36:51], v[188:191], v[224:227], v[36:51]
    v_exp_f32 v162, v162
    v_exp_f32 v163, v163
    s_nop 0
    v_mfma_f32_32x32x16_bf16 v[36:51], v[192:195], v[228:231], v[36:51]
    v_cvt_pk_bf16_f32 v216, v148, v149
    v_cvt_pk_bf16_f32 v217, v150, v151
    v_cvt_pk_bf16_f32 v218, v152, v153
    v_cvt_pk_bf16_f32 v219, v154, v155
    v_cvt_pk_bf16_f32 v220, v156, v157
    v_cvt_pk_bf16_f32 v221, v158, v159
    v_cvt_pk_bf16_f32 v222, v160, v161
    v_cvt_pk_bf16_f32 v223, v162, v163
    v_exp_f32 v132, v132
    v_exp_f32 v133, v133
    v_mfma_f32_32x32x16_bf16 v[148:163], v[20:23], v[124:127], v[52:67]
    v_exp_f32 v134, v134
    v_exp_f32 v135, v135
    v_exp_f32 v136, v136
    v_mfma_f32_32x32x16_bf16 v[148:163], v[24:27], v[128:131], v[148:163]
    v_exp_f32 v137, v137
    v_exp_f32 v138, v138
    v_exp_f32 v139, v139
    v_mfma_f32_32x32x16_bf16 v[148:163], v[28:31], v[124:127], v[148:163]
    v_exp_f32 v140, v140
    v_exp_f32 v141, v141
    v_exp_f32 v142, v142
    v_mfma_f32_32x32x16_bf16 v[148:163], v[32:35], v[128:131], v[148:163]
    v_exp_f32 v143, v143
    v_exp_f32 v144, v144
    v_exp_f32 v145, v145
    s_waitcnt lgkmcnt(4)
    v_mfma_f32_32x32x16_bf16 v[36:51], v[196:199], v[216:219], v[36:51]
    v_exp_f32 v146, v146
    v_exp_f32 v147, v147
    s_nop 0
    v_mfma_f32_32x32x16_bf16 v[36:51], v[200:203], v[220:223], v[36:51]
    v_cvt_pk_bf16_f32 v224, v132, v133
    v_cvt_pk_bf16_f32 v225, v134, v135
    v_cvt_pk_bf16_f32 v226, v136, v137
    v_cvt_pk_bf16_f32 v227, v138, v139
    v_cvt_pk_bf16_f32 v228, v140, v141
    v_cvt_pk_bf16_f32 v229, v142, v143
    v_cvt_pk_bf16_f32 v230, v144, v145
    v_cvt_pk_bf16_f32 v231, v146, v147
    v_exp_f32 v148, v148
    v_exp_f32 v149, v149
    s_waitcnt lgkmcnt(2)
    v_mfma_f32_32x32x16_bf16 v[36:51], v[204:207], v[224:227], v[36:51]
    v_exp_f32 v150, v150
    v_exp_f32 v151, v151
    v_exp_f32 v152, v152
    v_mfma_f32_32x32x16_bf16 v[36:51], v[208:211], v[228:231], v[36:51]
    v_exp_f32 v153, v153
    v_exp_f32 v154, v154
    v_exp_f32 v155, v155
    v_exp_f32 v156, v156
    v_exp_f32 v157, v157
    v_exp_f32 v158, v158
    v_exp_f32 v159, v159
    v_exp_f32 v160, v160
    v_exp_f32 v161, v161
    v_exp_f32 v162, v162
    v_exp_f32 v163, v163
    s_nop 0
    v_cvt_pk_bf16_f32 v216, v148, v149
    v_cvt_pk_bf16_f32 v217, v150, v151
    v_cvt_pk_bf16_f32 v218, v152, v153
    v_cvt_pk_bf16_f32 v219, v154, v155
    v_cvt_pk_bf16_f32 v220, v156, v157
    v_cvt_pk_bf16_f32 v221, v158, v159
    v_cvt_pk_bf16_f32 v222, v160, v161
    v_cvt_pk_bf16_f32 v223, v162, v163
    s_nop 1
    s_waitcnt lgkmcnt(0)
    v_mfma_f32_32x32x16_bf16 v[36:51], v[180:183], v[216:219], v[36:51]
    v_mfma_f32_32x32x16_bf16 v[36:51], v[184:187], v[220:223], v[36:51]
    s_nop 7
    s_nop 7
    v_rcp_f32 v7, v44
    s_nop 0
    v_mul_f32 v36, v36, v7
    v_mul_f32 v37, v37, v7
    v_mul_f32 v38, v38, v7
    v_mul_f32 v39, v39, v7
    v_mul_f32 v40, v40, v7
    v_mul_f32 v41, v41, v7
    v_mul_f32 v42, v42, v7
    v_mul_f32 v43, v43, v7
    v_cvt_pk_bf16_f32 v164, v36, v37
    v_cvt_pk_bf16_f32 v165, v38, v39
    v_cvt_pk_bf16_f32 v166, v40, v41
    v_cvt_pk_bf16_f32 v167, v42, v43
    buffer_store_dwordx4 v[164:167], v5, s[12:15], s55 offen sc1
    s_sub_u32 s63, s52, 7
K2_END:
    s_endpgm
.globl oproj_kernel
.p2align 8
.type oproj_kernel,@function
oproj_kernel:
    s_cmp_ge_u32 s2, 256
    s_cbranch_scc1 K3_END
    s_load_dwordx4 s[4:7], s[0:1], 16
    s_load_dwordx2 s[8:9], s[0:1], 40
    v_lshrrev_b32 v2, 6, v0
    v_and_b32 v1, 63, v0
    s_and_b32 s25, s2, 1
    s_lshl_b32 s25, s25, 2
    s_bfe_u32 s24, s2, 0x20003
    s_add_u32 s25, s25, s24
    v_readfirstlane_b32 s26, v2
    s_bfe_u32 s24, s2, 0x20001
    s_lshl_b32 s24, s24, 3
    s_lshr_b32 s27, s2, 5
    s_add_u32 s24, s24, s27
    s_cmp_lt_u32 s26, 4
    s_cbranch_scc1 K3_COMPUTE
    s_sub_u32 s26, s26, 4
    v_lshlrev_b32 v5, 4, v1
    v_lshrrev_b32 v6, 4, v1
    v_and_b32 v6, 1, v6
    v_lshlrev_b32 v6, 2, v6
    v_and_b32 v7, 7, v1
    v_xor_b32 v6, v6, v7
    v_lshlrev_b32 v6, 4, v6
    v_lshrrev_b32 v7, 3, v1
    v_lshl_add_u32 v6, v7, 10, v6
    s_and_b32 s27, s26, 1
    s_lshr_b32 s28, s26, 1
    s_lshl_b32 s33, s24, 16
    s_lshl_b32 s34, s27, 15
    s_add_u32 s33, s33, s34
    s_lshl_b32 s35, s28, 11
    s_add_u32 s33, s33, s35
    s_add_u32 s33, s33, 6291456
    s_add_u32 s34, s34, s35
    s_lshl_b32 s35, s26, 14
    s_lshl_b32 s36, s25, 7
    s_add_u32 s35, s35, s36
    s_lshl_b32 s36, s26, 11
    s_add_u32 s36, s36, 0x10000
    s_waitcnt lgkmcnt(0)
    s_mov_b32 s12, s4
    s_and_b32 s13, s5, 0xffff
    s_mov_b32 s14, 0x80000
    s_mov_b32 s15, 0x00020000
    s_mov_b32 s16, s8
    s_and_b32 s17, s9, 0xffff
    s_mov_b32 s18, 0x800000
    s_mov_b32 s19, 0x00020000
    s_lshr_b32 s39, s2, 3
    s_add_u32 s40, s39, 0
    s_and_b32 s40, s40, 7
    s_lshl_b32 s41, s40, 12
    s_add_u32 s41, s41, s33
    s_lshl_b32 s42, s40, 16
    s_add_u32 s42, s42, s35
    s_add_u32 s37, s41, 0
    s_add_u32 m0, s34, 0
    s_nop 0
    buffer_load_dwordx4 v5, s[16:19], s37 offen lds
    s_add_u32 s37, s41, 1024
    s_add_u32 m0, s34, 1024
    s_nop 0
    buffer_load_dwordx4 v5, s[16:19], s37 offen lds
    s_add_u32 s37, s42, 0
    s_add_u32 m0, s36, 0
    s_nop 0
    buffer_load_dwordx4 v6, s[12:15], s37 offen lds
    s_add_u32 s37, s42, 8192
    s_add_u32 m0, s36, 1024
    s_nop 0
    buffer_load_dwordx4 v6, s[12:15], s37 offen lds
    s_add_u32 s40, s39, 1
    s_and_b32 s40, s40, 7
    s_lshl_b32 s41, s40, 12
    s_add_u32 s41, s41, s33
    s_lshl_b32 s42, s40, 16
    s_add_u32 s42, s42, s35
    s_add_u32 s37, s41, 0
    s_add_u32 m0, s34, 4096
    s_nop 0
    buffer_load_dwordx4 v5, s[16:19], s37 offen lds
    s_add_u32 s37, s41, 1024
    s_add_u32 m0, s34, 5120
    s_nop 0
    buffer_load_dwordx4 v5, s[16:19], s37 offen lds
    s_add_u32 s37, s42, 0
    s_add_u32 m0, s36, 8192
    s_nop 0
    buffer_load_dwordx4 v6, s[12:15], s37 offen lds
    s_add_u32 s37, s42, 8192
    s_add_u32 m0, s36, 9216
    s_nop 0
    buffer_load_dwordx4 v6, s[12:15], s37 offen lds
    s_add_u32 s40, s39, 2
    s_and_b32 s40, s40, 7
    s_lshl_b32 s41, s40, 12
    s_add_u32 s41, s41, s33
    s_lshl_b32 s42, s40, 16
    s_add_u32 s42, s42, s35
    s_add_u32 s37, s41, 0
    s_add_u32 m0, s34, 8192
    s_nop 0
    buffer_load_dwordx4 v5, s[16:19], s37 offen lds
    s_add_u32 s37, s41, 1024
    s_add_u32 m0, s34, 9216
    s_nop 0
    buffer_load_dwordx4 v5, s[16:19], s37 offen lds
    s_add_u32 s37, s42, 0
    s_add_u32 m0, s36, 16384
    s_nop 0
    buffer_load_dwordx4 v6, s[12:15], s37 offen lds
    s_add_u32 s37, s42, 8192
    s_add_u32 m0, s36, 17408
    s_nop 0
    buffer_load_dwordx4 v6, s[12:15], s37 offen lds
    s_add_u32 s40, s39, 3
    s_and_b32 s40, s40, 7
    s_lshl_b32 s41, s40, 12
    s_add_u32 s41, s41, s33
    s_lshl_b32 s42, s40, 16
    s_add_u32 s42, s42, s35
    s_add_u32 s37, s41, 0
    s_add_u32 m0, s34, 12288
    s_nop 0
    buffer_load_dwordx4 v5, s[16:19], s37 offen lds
    s_add_u32 s37, s41, 1024
    s_add_u32 m0, s34, 13312
    s_nop 0
    buffer_load_dwordx4 v5, s[16:19], s37 offen lds
    s_add_u32 s37, s42, 0
    s_add_u32 m0, s36, 24576
    s_nop 0
    buffer_load_dwordx4 v6, s[12:15], s37 offen lds
    s_add_u32 s37, s42, 8192
    s_add_u32 m0, s36, 25600
    s_nop 0
    buffer_load_dwordx4 v6, s[12:15], s37 offen lds
    s_waitcnt vmcnt(12)
    s_barrier
    s_add_u32 s40, s39, 4
    s_and_b32 s40, s40, 7
    s_lshl_b32 s41, s40, 12
    s_add_u32 s41, s41, s33
    s_lshl_b32 s42, s40, 16
    s_add_u32 s42, s42, s35
    s_add_u32 s37, s41, 0
    s_add_u32 m0, s34, 16384
    s_nop 0
    buffer_load_dwordx4 v5, s[16:19], s37 offen lds
    s_add_u32 s37, s41, 1024
    s_add_u32 m0, s34, 17408
    s_nop 0
    buffer_load_dwordx4 v5, s[16:19], s37 offen lds
    s_add_u32 s37, s42, 0
    s_add_u32 m0, s36, 32768
    s_nop 0
    buffer_load_dwordx4 v6, s[12:15], s37 offen lds
    s_add_u32 s37, s42, 8192
    s_add_u32 m0, s36, 33792
    s_nop 0
    buffer_load_dwordx4 v6, s[12:15], s37 offen lds
    s_waitcnt vmcnt(12)
    s_barrier
    s_add_u32 s40, s39, 5
    s_and_b32 s40, s40, 7
    s_lshl_b32 s41, s40, 12
    s_add_u32 s41, s41, s33
    s_lshl_b32 s42, s40, 16
    s_add_u32 s42, s42, s35
    s_add_u32 s37, s41, 0
    s_add_u32 m0, s34, 20480
    s_nop 0
    buffer_load_dwordx4 v5, s[16:19], s37 offen lds
    s_add_u32 s37, s41, 1024
    s_add_u32 m0, s34, 21504
    s_nop 0
    buffer_load_dwordx4 v5, s[16:19], s37 offen lds
    s_add_u32 s37, s42, 0
    s_add_u32 m0, s36, 40960
    s_nop 0
    buffer_load_dwordx4 v6, s[12:15], s37 offen lds
    s_add_u32 s37, s42, 8192
    s_add_u32 m0, s36, 41984
    s_nop 0
    buffer_load_dwordx4 v6, s[12:15], s37 offen lds
    s_waitcnt vmcnt(12)
    s_barrier
    s_add_u32 s40, s39, 6
    s_and_b32 s40, s40, 7
    s_lshl_b32 s41, s40, 12
    s_add_u32 s41, s41, s33
    s_lshl_b32 s42, s40, 16
    s_add_u32 s42, s42, s35
    s_add_u32 s37, s41, 0
    s_add_u32 m0, s34, 24576
    s_nop 0
    buffer_load_dwordx4 v5, s[16:19], s37 offen lds
    s_add_u32 s37, s41, 1024
    s_add_u32 m0, s34, 25600
    s_nop 0
    buffer_load_dwordx4 v5, s[16:19], s37 offen lds
    s_add_u32 s37, s42, 0
    s_add_u32 m0, s36, 49152
    s_nop 0
    buffer_load_dwordx4 v6, s[12:15], s37 offen lds
    s_add_u32 s37, s42, 8192
    s_add_u32 m0, s36, 50176
    s_nop 0
    buffer_load_dwordx4 v6, s[12:15], s37 offen lds
    s_waitcnt vmcnt(12)
    s_barrier
    s_add_u32 s40, s39, 7
    s_and_b32 s40, s40, 7
    s_lshl_b32 s41, s40, 12
    s_add_u32 s41, s41, s33
    s_lshl_b32 s42, s40, 16
    s_add_u32 s42, s42, s35
    s_add_u32 s37, s41, 0
    s_add_u32 m0, s34, 28672
    s_nop 0
    buffer_load_dwordx4 v5, s[16:19], s37 offen lds
    s_add_u32 s37, s41, 1024
    s_add_u32 m0, s34, 29696
    s_nop 0
    buffer_load_dwordx4 v5, s[16:19], s37 offen lds
    s_add_u32 s37, s42, 0
    s_add_u32 m0, s36, 57344
    s_nop 0
    buffer_load_dwordx4 v6, s[12:15], s37 offen lds
    s_add_u32 s37, s42, 8192
    s_add_u32 m0, s36, 58368
    s_nop 0
    buffer_load_dwordx4 v6, s[12:15], s37 offen lds
    s_waitcnt vmcnt(12)
    s_barrier
    s_waitcnt vmcnt(8)
    s_barrier
    s_waitcnt vmcnt(4)
    s_barrier
    s_waitcnt vmcnt(0)
    s_barrier
    s_endpgm
K3_COMPUTE:
    v_and_b32 v3, 31, v1
    v_lshrrev_b32 v4, 5, v1
    s_and_b32 s27, s26, 1
    s_lshr_b32 s28, s26, 1
    v_lshlrev_b32 v11, 5, v3
    v_lshl_add_u32 v11, v4, 4, v11
    s_lshl_b32 s29, s27, 15
    v_add_u32 v11, s29, v11
    v_lshrrev_b32 v8, 2, v1
    v_and_b32 v8, 3, v8
    v_lshrrev_b32 v9, 1, v8
    v_xor_b32 v9, s28, v9
    v_lshlrev_b32 v9, 6, v9
    v_lshl_add_u32 v8, v4, 2, v8
    v_lshl_add_u32 v8, v8, 7, v9
    v_lshrrev_b32 v9, 4, v1
    v_and_b32 v9, 1, v9
    v_lshl_add_u32 v8, v9, 5, v8
    v_and_b32 v9, 1, v1
    v_lshl_add_u32 v8, v9, 4, v8
    v_lshrrev_b32 v9, 1, v1
    v_and_b32 v9, 1, v9
    v_lshl_add_u32 v8, v9, 3, v8
    v_add_u32 v8, 0x10000, v8
    v_lshlrev_b32 v10, 10, v3
    v_lshl_add_u32 v10, v4, 4, v10
    s_lshl_b32 s31, s24, 16
    s_lshl_b32 s32, s27, 15
    s_add_u32 s31, s31, s32
    s_lshl_b32 s32, s25, 7
    s_add_u32 s31, s31, s32
    s_lshl_b32 s32, s28, 6
    s_add_u32 s31, s31, s32
    v_mov_b32 v16, 0
    v_mov_b32 v17, 0
    v_mov_b32 v18, 0
    v_mov_b32 v19, 0
    v_mov_b32 v20, 0
    v_mov_b32 v21, 0
    v_mov_b32 v22, 0
    v_mov_b32 v23, 0
    v_mov_b32 v24, 0
    v_mov_b32 v25, 0
    v_mov_b32 v26, 0
    v_mov_b32 v27, 0
    v_mov_b32 v28, 0
    v_mov_b32 v29, 0
    v_mov_b32 v30, 0
    v_mov_b32 v31, 0
    s_waitcnt lgkmcnt(0)
    s_mov_b32 s20, s6
    s_and_b32 s21, s7, 0xffff
    s_mov_b32 s22, 0x200000
    s_mov_b32 s23, 0x00020000
    s_barrier
    ds_read_b128 v[32:35], v11 offset:0
    ds_read_b64_tr_b16 v[36:37], v8 offset:0
    ds_read_b64_tr_b16 v[38:39], v8 offset:1024
    ds_read_b128 v[40:43], v11 offset:1024
    ds_read_b64_tr_b16 v[44:45], v8 offset:2048
    ds_read_b64_tr_b16 v[46:47], v8 offset:3072
    ds_read_b128 v[48:51], v11 offset:2048
    ds_read_b64_tr_b16 v[52:53], v8 offset:4096
    ds_read_b64_tr_b16 v[54:55], v8 offset:5120
    ds_read_b128 v[56:59], v11 offset:3072
    ds_read_b64_tr_b16 v[60:61], v8 offset:6144
    ds_read_b64_tr_b16 v[62:63], v8 offset:7168
    s_waitcnt lgkmcnt(9)
    v_mfma_f32_32x32x16_bf16 v[16:31], v[36:39], v[32:35], v[16:31]
    s_waitcnt lgkmcnt(6)
    v_mfma_f32_32x32x16_bf16 v[16:31], v[44:47], v[40:43], v[16:31]
    s_waitcnt lgkmcnt(3)
    v_mfma_f32_32x32x16_bf16 v[16:31], v[52:55], v[48:51], v[16:31]
    s_waitcnt lgkmcnt(0)
    v_mfma_f32_32x32x16_bf16 v[16:31], v[60:63], v[56:59], v[16:31]
    s_barrier
    ds_read_b128 v[32:35], v11 offset:4096
    ds_read_b64_tr_b16 v[36:37], v8 offset:8192
    ds_read_b64_tr_b16 v[38:39], v8 offset:9216
    ds_read_b128 v[40:43], v11 offset:5120
    ds_read_b64_tr_b16 v[44:45], v8 offset:10240
    ds_read_b64_tr_b16 v[46:47], v8 offset:11264
    ds_read_b128 v[48:51], v11 offset:6144
    ds_read_b64_tr_b16 v[52:53], v8 offset:12288
    ds_read_b64_tr_b16 v[54:55], v8 offset:13312
    ds_read_b128 v[56:59], v11 offset:7168
    ds_read_b64_tr_b16 v[60:61], v8 offset:14336
    ds_read_b64_tr_b16 v[62:63], v8 offset:15360
    s_waitcnt lgkmcnt(9)
    v_mfma_f32_32x32x16_bf16 v[16:31], v[36:39], v[32:35], v[16:31]
    s_waitcnt lgkmcnt(6)
    v_mfma_f32_32x32x16_bf16 v[16:31], v[44:47], v[40:43], v[16:31]
    s_waitcnt lgkmcnt(3)
    v_mfma_f32_32x32x16_bf16 v[16:31], v[52:55], v[48:51], v[16:31]
    s_waitcnt lgkmcnt(0)
    v_mfma_f32_32x32x16_bf16 v[16:31], v[60:63], v[56:59], v[16:31]
    s_barrier
    ds_read_b128 v[32:35], v11 offset:8192
    ds_read_b64_tr_b16 v[36:37], v8 offset:16384
    ds_read_b64_tr_b16 v[38:39], v8 offset:17408
    ds_read_b128 v[40:43], v11 offset:9216
    ds_read_b64_tr_b16 v[44:45], v8 offset:18432
    ds_read_b64_tr_b16 v[46:47], v8 offset:19456
    ds_read_b128 v[48:51], v11 offset:10240
    ds_read_b64_tr_b16 v[52:53], v8 offset:20480
    ds_read_b64_tr_b16 v[54:55], v8 offset:21504
    ds_read_b128 v[56:59], v11 offset:11264
    ds_read_b64_tr_b16 v[60:61], v8 offset:22528
    ds_read_b64_tr_b16 v[62:63], v8 offset:23552
    s_waitcnt lgkmcnt(9)
    v_mfma_f32_32x32x16_bf16 v[16:31], v[36:39], v[32:35], v[16:31]
    s_waitcnt lgkmcnt(6)
    v_mfma_f32_32x32x16_bf16 v[16:31], v[44:47], v[40:43], v[16:31]
    s_waitcnt lgkmcnt(3)
    v_mfma_f32_32x32x16_bf16 v[16:31], v[52:55], v[48:51], v[16:31]
    s_waitcnt lgkmcnt(0)
    v_mfma_f32_32x32x16_bf16 v[16:31], v[60:63], v[56:59], v[16:31]
    s_barrier
    ds_read_b128 v[32:35], v11 offset:12288
    ds_read_b64_tr_b16 v[36:37], v8 offset:24576
    ds_read_b64_tr_b16 v[38:39], v8 offset:25600
    ds_read_b128 v[40:43], v11 offset:13312
    ds_read_b64_tr_b16 v[44:45], v8 offset:26624
    ds_read_b64_tr_b16 v[46:47], v8 offset:27648
    ds_read_b128 v[48:51], v11 offset:14336
    ds_read_b64_tr_b16 v[52:53], v8 offset:28672
    ds_read_b64_tr_b16 v[54:55], v8 offset:29696
    ds_read_b128 v[56:59], v11 offset:15360
    ds_read_b64_tr_b16 v[60:61], v8 offset:30720
    ds_read_b64_tr_b16 v[62:63], v8 offset:31744
    s_waitcnt lgkmcnt(9)
    v_mfma_f32_32x32x16_bf16 v[16:31], v[36:39], v[32:35], v[16:31]
    s_waitcnt lgkmcnt(6)
    v_mfma_f32_32x32x16_bf16 v[16:31], v[44:47], v[40:43], v[16:31]
    s_waitcnt lgkmcnt(3)
    v_mfma_f32_32x32x16_bf16 v[16:31], v[52:55], v[48:51], v[16:31]
    s_waitcnt lgkmcnt(0)
    v_mfma_f32_32x32x16_bf16 v[16:31], v[60:63], v[56:59], v[16:31]
    s_barrier
    ds_read_b128 v[32:35], v11 offset:16384
    ds_read_b64_tr_b16 v[36:37], v8 offset:32768
    ds_read_b64_tr_b16 v[38:39], v8 offset:33792
    ds_read_b128 v[40:43], v11 offset:17408
    ds_read_b64_tr_b16 v[44:45], v8 offset:34816
    ds_read_b64_tr_b16 v[46:47], v8 offset:35840
    ds_read_b128 v[48:51], v11 offset:18432
    ds_read_b64_tr_b16 v[52:53], v8 offset:36864
    ds_read_b64_tr_b16 v[54:55], v8 offset:37888
    ds_read_b128 v[56:59], v11 offset:19456
    ds_read_b64_tr_b16 v[60:61], v8 offset:38912
    ds_read_b64_tr_b16 v[62:63], v8 offset:39936
    s_waitcnt lgkmcnt(9)
    v_mfma_f32_32x32x16_bf16 v[16:31], v[36:39], v[32:35], v[16:31]
    s_waitcnt lgkmcnt(6)
    v_mfma_f32_32x32x16_bf16 v[16:31], v[44:47], v[40:43], v[16:31]
    s_waitcnt lgkmcnt(3)
    v_mfma_f32_32x32x16_bf16 v[16:31], v[52:55], v[48:51], v[16:31]
    s_waitcnt lgkmcnt(0)
    v_mfma_f32_32x32x16_bf16 v[16:31], v[60:63], v[56:59], v[16:31]
    s_barrier
    ds_read_b128 v[32:35], v11 offset:20480
    ds_read_b64_tr_b16 v[36:37], v8 offset:40960
    ds_read_b64_tr_b16 v[38:39], v8 offset:41984
    ds_read_b128 v[40:43], v11 offset:21504
    ds_read_b64_tr_b16 v[44:45], v8 offset:43008
    ds_read_b64_tr_b16 v[46:47], v8 offset:44032
    ds_read_b128 v[48:51], v11 offset:22528
    ds_read_b64_tr_b16 v[52:53], v8 offset:45056
    ds_read_b64_tr_b16 v[54:55], v8 offset:46080
    ds_read_b128 v[56:59], v11 offset:23552
    ds_read_b64_tr_b16 v[60:61], v8 offset:47104
    ds_read_b64_tr_b16 v[62:63], v8 offset:48128
    s_waitcnt lgkmcnt(9)
    v_mfma_f32_32x32x16_bf16 v[16:31], v[36:39], v[32:35], v[16:31]
    s_waitcnt lgkmcnt(6)
    v_mfma_f32_32x32x16_bf16 v[16:31], v[44:47], v[40:43], v[16:31]
    s_waitcnt lgkmcnt(3)
    v_mfma_f32_32x32x16_bf16 v[16:31], v[52:55], v[48:51], v[16:31]
    s_waitcnt lgkmcnt(0)
    v_mfma_f32_32x32x16_bf16 v[16:31], v[60:63], v[56:59], v[16:31]
    s_barrier
    ds_read_b128 v[32:35], v11 offset:24576
    ds_read_b64_tr_b16 v[36:37], v8 offset:49152
    ds_read_b64_tr_b16 v[38:39], v8 offset:50176
    ds_read_b128 v[40:43], v11 offset:25600
    ds_read_b64_tr_b16 v[44:45], v8 offset:51200
    ds_read_b64_tr_b16 v[46:47], v8 offset:52224
    ds_read_b128 v[48:51], v11 offset:26624
    ds_read_b64_tr_b16 v[52:53], v8 offset:53248
    ds_read_b64_tr_b16 v[54:55], v8 offset:54272
    ds_read_b128 v[56:59], v11 offset:27648
    ds_read_b64_tr_b16 v[60:61], v8 offset:55296
    ds_read_b64_tr_b16 v[62:63], v8 offset:56320
    s_waitcnt lgkmcnt(9)
    v_mfma_f32_32x32x16_bf16 v[16:31], v[36:39], v[32:35], v[16:31]
    s_waitcnt lgkmcnt(6)
    v_mfma_f32_32x32x16_bf16 v[16:31], v[44:47], v[40:43], v[16:31]
    s_waitcnt lgkmcnt(3)
    v_mfma_f32_32x32x16_bf16 v[16:31], v[52:55], v[48:51], v[16:31]
    s_waitcnt lgkmcnt(0)
    v_mfma_f32_32x32x16_bf16 v[16:31], v[60:63], v[56:59], v[16:31]
    s_barrier
    ds_read_b128 v[32:35], v11 offset:28672
    ds_read_b64_tr_b16 v[36:37], v8 offset:57344
    ds_read_b64_tr_b16 v[38:39], v8 offset:58368
    ds_read_b128 v[40:43], v11 offset:29696
    ds_read_b64_tr_b16 v[44:45], v8 offset:59392
    ds_read_b64_tr_b16 v[46:47], v8 offset:60416
    ds_read_b128 v[48:51], v11 offset:30720
    ds_read_b64_tr_b16 v[52:53], v8 offset:61440
    ds_read_b64_tr_b16 v[54:55], v8 offset:62464
    ds_read_b128 v[56:59], v11 offset:31744
    ds_read_b64_tr_b16 v[60:61], v8 offset:63488
    ds_read_b64_tr_b16 v[62:63], v8 offset:64512
    s_waitcnt lgkmcnt(9)
    v_mfma_f32_32x32x16_bf16 v[16:31], v[36:39], v[32:35], v[16:31]
    s_waitcnt lgkmcnt(6)
    v_mfma_f32_32x32x16_bf16 v[16:31], v[44:47], v[40:43], v[16:31]
    s_waitcnt lgkmcnt(3)
    v_mfma_f32_32x32x16_bf16 v[16:31], v[52:55], v[48:51], v[16:31]
    s_waitcnt lgkmcnt(0)
    v_mfma_f32_32x32x16_bf16 v[16:31], v[60:63], v[56:59], v[16:31]
    s_lshl_b32 s32, s27, 5
    v_add_u32 v12, s32, v3
    v_mul_u32_u24 v12, 144, v12
    v_lshl_add_u32 v12, v4, 4, v12
    s_lshl_b32 s32, s28, 6
    s_add_u32 s32, s32, 131072
    v_add_u32 v12, s32, v12
    v_lshrrev_b32 v13, 3, v1
    s_lshl_b32 s32, s26, 4
    v_add_u32 v13, s32, v13
    v_and_b32 v14, 7, v1
    v_lshlrev_b32 v15, 10, v13
    v_lshl_add_u32 v15, v14, 4, v15
    v_mul_u32_u24 v13, 144, v13
    v_lshl_add_u32 v13, v14, 4, v13
    v_add_u32 v13, 131072, v13
    s_lshl_b32 s31, s24, 16
    s_lshl_b32 s32, s25, 7
    s_add_u32 s31, s31, s32
    v_cvt_pk_bf16_f32 v32, v16, v17
    v_cvt_pk_bf16_f32 v33, v18, v19
    v_cvt_pk_bf16_f32 v34, v20, v21
    v_cvt_pk_bf16_f32 v35, v22, v23
    ds_write_b128 v12, v[32:35] offset:0
    v_cvt_pk_bf16_f32 v36, v24, v25
    v_cvt_pk_bf16_f32 v37, v26, v27
    v_cvt_pk_bf16_f32 v38, v28, v29
    v_cvt_pk_bf16_f32 v39, v30, v31
    ds_write_b128 v12, v[36:39] offset:32
    s_waitcnt lgkmcnt(0)
    s_barrier
    ds_read_b128 v[40:43], v13 offset:0
    ds_read_b128 v[44:47], v13 offset:1152
    s_waitcnt lgkmcnt(1)
    buffer_store_dwordx4 v[40:43], v15, s[20:23], s31 offen offset:0 sc1
    v_add_u32 v16, 8192, v15
    s_waitcnt lgkmcnt(0)
    buffer_store_dwordx4 v[44:47], v16, s[20:23], s31 offen sc1
    s_endpgm
K3_END:
    s_endpgm
.section .rodata,"a"
.p2align 6
.amdhsa_kernel qkv_kernel
  .amdhsa_next_free_vgpr 100
  .amdhsa_next_free_sgpr 40
  .amdhsa_accum_offset 100
  .amdhsa_group_segment_fixed_size 0
  .amdhsa_kernarg_size 48
  .amdhsa_user_sgpr_count 2
  .amdhsa_user_sgpr_kernarg_segment_ptr 1
  .amdhsa_system_sgpr_workgroup_id_x 1
.end_amdhsa_kernel
.p2align 6
.amdhsa_kernel attn_kernel
  .amdhsa_next_free_vgpr 256
  .amdhsa_next_free_sgpr 80
  .amdhsa_accum_offset 256
  .amdhsa_group_segment_fixed_size 0
  .amdhsa_kernarg_size 48
  .amdhsa_user_sgpr_count 2
  .amdhsa_user_sgpr_kernarg_segment_ptr 1
  .amdhsa_system_sgpr_workgroup_id_x 1
.end_amdhsa_kernel
.p2align 6
.amdhsa_kernel oproj_kernel
  .amdhsa_next_free_vgpr 64
  .amdhsa_next_free_sgpr 48
  .amdhsa_accum_offset 64
  .amdhsa_group_segment_fixed_size 0
  .amdhsa_kernarg_size 48
  .amdhsa_user_sgpr_count 2
  .amdhsa_user_sgpr_kernarg_segment_ptr 1
  .amdhsa_system_sgpr_workgroup_id_x 1
.end_amdhsa_kernel
```
